```python
import torch

def _softmax(x, axis=-1):
    return torch.softmax(x, dim=axis)
def _gelu(x):
    return torch.nn.functional.gelu(x, approximate="tanh")
def _silu(x):
    return torch.nn.functional.silu(x)
def _sigmoid(x):
    return torch.sigmoid(x)
def _layernorm(x, axis=-1, eps=1e-5):
    m = x.mean(dim=axis, keepdim=True)
    v = x.var(dim=axis, keepdim=True, unbiased=False)
    return (x - m) / torch.sqrt(v + eps)
def _scatter_add(tgt, idx, src, axis=0):
    return tgt.clone().index_add_(axis, idx, src)
def _segment_sum(src, seg, n):
    out = torch.zeros((n,) + src.shape[1:], dtype=src.dtype)
    return out.index_add_(0, seg, src)
def _pad(x, pw):
    flat = tuple(v for pair in reversed(pw) for v in pair)
    return torch.nn.functional.pad(x, flat)

kernel_name = 'gated_mix__ssm_conv_s4d__dense_activation_silu__prompt'

def setup_inputs():

    _w = (lambda a: (lambda t: t.to(torch.bfloat16) if t.is_floating_point() else t)(torch.as_tensor(a)))
    def _A_setup():
        Bsz, L, D, N = 1, 2048, 512, 128
        return {
            "u": _w((lambda *s: torch.randn(*s, dtype=torch.bfloat16) * 0.05)(Bsz, L, D)),
            "log_A_real": _w((lambda *s: torch.randn(*s, dtype=torch.bfloat16) * 6.4)(D, N) * 0.5),
            "A_imag": _w((lambda *s: torch.randn(*s, dtype=torch.bfloat16) * 0.05)(D, N) * 3.14),
            "C_real": _w((lambda *s: torch.randn(*s, dtype=torch.bfloat16) * 0.2)(D, N) / N ** 0.5),
            "C_imag": _w((lambda *s: torch.randn(*s, dtype=torch.bfloat16) * 0.2)(D, N) / N ** 0.5),
            "log_dt": _w((lambda *s: torch.randn(*s, dtype=torch.bfloat16) * 0.05)(D) * 0.5 - 4.0),
            "D_skip": _w((lambda *s: torch.randn(*s, dtype=torch.bfloat16) * 0.05)(D)),
        }
    _A_in = _A_setup()

    def _B_setup():
        B, S, D, F = 1, 2048, 512, 1792
        return {
            "x": _w((lambda *s: torch.randn(*s, dtype=torch.bfloat16) * 0.05)(B, S, D)),
            "w1": _w((lambda *s: torch.randn(*s, dtype=torch.bfloat16) * 6.4)(D, F) * (D ** -0.5)),
            "w2": _w((lambda *s: torch.randn(*s, dtype=torch.bfloat16) * 0.2)(F, D) * (F ** -0.5)),
        }
    _B_in = _B_setup()

    return {
        "A_u": _A_in["u"],
        "A_log_A_real": _A_in["log_A_real"],
        "A_A_imag": _A_in["A_imag"],
        "A_C_real": _A_in["C_real"],
        "A_C_imag": _A_in["C_imag"],
        "A_log_dt": _A_in["log_dt"],
        "A_D_skip": _A_in["D_skip"],
        "B_x": _B_in["x"],
        "B_w1": _B_in["w1"],
        "B_w2": _B_in["w2"],
        "gate_w": _w((lambda *s: torch.randn(*s, dtype=torch.bfloat16) * 0.05)(512) * 16.0),
    }

def reference(A_u, A_log_A_real, A_A_imag, A_C_real, A_C_imag, A_log_dt, A_D_skip, B_x, B_w1, B_w2, gate_w):
    def _A_ref(u, log_A_real, A_imag, C_real, C_imag, log_dt, D_skip):
        L = u.shape[1]
        dt = torch.exp(log_dt)
        A = -torch.exp(log_A_real) + 1j * A_imag
        C = (C_real + 1j * C_imag) * dt[:, None]
        pos = (lambda x, dt: x.to(dt))(torch.arange(L), log_dt.dtype)
        P = torch.exp((A * dt[:, None])[:, :, None] * pos[None, None, :])
        K = 2.0 * torch.einsum("dn,dnl->dl", C, P).real
        L2 = 2 * L
        u_t = (lambda x, *d: x.permute(*d))(u, 0, 2, 1)
        Kf = (lambda x, *a, **k: torch.fft.rfft(x.float(), *a, **k))(K, L2)
        Uf = (lambda x, *a, **k: torch.fft.rfft(x.float(), *a, **k))(u_t, L2)
        y = (lambda x, *a, **k: torch.fft.irfft(x, *a, **k).to(torch.bfloat16))(Uf * Kf[None, :, :], L2)[:, :, :L]
        y = (lambda x, *d: x.permute(*d))(y, 0, 2, 1)
        return y + u * D_skip[None, None, :]

    def _B_ref(x, w1, w2):
        h = torch.einsum("bsd,df->bsf", x, w1)
        h = _silu(h)
        out = torch.einsum("bsf,fd->bsd", h, w2)
        return out

    x = A_u
    g = _sigmoid((x * gate_w).sum(-1, keepdims=True))
    a = _A_ref(x, A_log_A_real, A_A_imag, A_C_real, A_C_imag, A_log_dt, A_D_skip)
    b = _B_ref(x, B_w1, B_w2)
    return g * a + (1 - g) * b
```

```asm
; @launch grid=(256,1,1) block=(512,1,1) lds=163840
.amdgcn_target "amdgcn-amd-amdhsa--gfx950"
.text
.globl gated_mix__ssm_conv_s4d__dense_activation_silu__prompt_kernel
.p2align 8
.type gated_mix__ssm_conv_s4d__dense_activation_silu__prompt_kernel,@function
gated_mix__ssm_conv_s4d__dense_activation_silu__prompt_kernel:
  s_cmp_ge_u32 s2, 256
  s_cbranch_scc1 K_END
  s_load_dwordx16 s[36:51], s[0:1], 0
  s_load_dwordx8 s[52:59], s[0:1], 64
  s_load_dwordx4 s[60:63], s[0:1], 96
  v_lshrrev_b32 v2, 6, v0
  v_and_b32 v1, 63, v0
  v_readfirstlane_b32 s26, v2
  s_and_b32 s24, s2, 7
  s_lshr_b32 s25, s2, 3
  s_mov_b32 s27, s26
  v_and_b32 v2, 31, v1
  v_lshlrev_b32 v2, 2, v2
  v_add_u32 v2, 162816, v2
  v_mov_b32 v3, 0
  ds_write_b32 v2, v3
  s_cmp_ge_u32 s26, 4
  s_cbranch_scc1 K_SSM
  s_setprio 2
  s_cmp_ge_u32 s25, 28
  s_cbranch_scc1 K_IDLE
  s_and_b32 s64, s25, 3
  s_and_b32 s69, s24, 6
  s_lshl_b32 s69, s69, 1
  s_add_u32 s64, s64, s69
  s_and_b32 s69, s24, 1
  s_mul_i32 s69, s69, 7
  s_lshr_b32 s65, s25, 2
  s_add_u32 s65, s65, s69
  v_lshrrev_b32 v30, 3, v1
  v_and_b32 v31, 7, v1
  v_lshrrev_b32 v32, 4, v1
  v_xor_b32 v33, v31, v32
  v_xor_b32 v34, 4, v33
  v_lshlrev_b32 v30, 10, v30
  v_lshl_add_u32 v2, v33, 4, v30
  v_lshl_add_u32 v3, v34, 4, v30
  v_add_u32 v3, 7168, v3
  v_add_u32 v4, 14336, v2
  v_add_u32 v5, 14336, v3
  s_lshl_b32 s66, s64, 17
  s_lshl_b32 s69, s26, 15
  s_add_u32 s66, s66, s69
  v_and_b32 v31, 15, v1
  v_lshlrev_b32 v33, 2, v32
  v_xor_b32 v31, v31, v33
  v_mul_u32_u24 v33, 3584, v32
  v_lshl_add_u32 v6, v31, 4, v33
  v_add_u32 v7, 13312, v6
  v_add_u32 v8, 26624, v6
  v_add_u32 v9, 39936, v6
  s_mul_i32 s67, s26, 57344
  s_lshl_b32 s69, s65, 8
  s_add_u32 s67, s67, s69
  s_lshl_b32 s68, s26, 12
  s_mov_b32 s84, 0
  s_lshr_b32 s69, s24, 1
  s_mul_i32 s69, s69, 2
  s_add_u32 s84, s84, s69
  s_and_b32 s69, s24, 1
  s_mul_i32 s69, s69, 1
  s_add_u32 s84, s84, s69
  s_waitcnt lgkmcnt(0)
  s_mov_b32 s4, s36
  s_and_b32 s5, s37, 0xffff
  s_mov_b32 s6, 2097152
  s_mov_b32 s7, 0x20000
  s_mov_b32 s8, s52
  s_and_b32 s9, s53, 0xffff
  s_mov_b32 s10, 1835008
  s_mov_b32 s11, 0x20000
  s_add_u32 s71, s84, 0
  s_and_b32 s71, s71, 7
  s_lshl_b32 s70, s71, 7
  s_add_u32 m0, s68, 0
  s_add_u32 s70, s70, s66
  buffer_load_dwordx4 v2, s[4:7], s70 offen offset:0  lds
  buffer_load_dwordx4 v3, s[4:7], s70 offen offset:1024  lds
  buffer_load_dwordx4 v4, s[4:7], s70 offen offset:2048  lds
  buffer_load_dwordx4 v5, s[4:7], s70 offen offset:3072  lds
  s_mul_i32 s70, s71, 229376
  s_add_u32 m0, s68, 16384
  s_add_u32 s70, s70, s67
  buffer_load_dwordx4 v6, s[8:11], s70 offen offset:0  lds
  buffer_load_dwordx4 v7, s[8:11], s70 offen offset:1024  lds
  buffer_load_dwordx4 v8, s[8:11], s70 offen offset:2048  lds
  buffer_load_dwordx4 v9, s[8:11], s70 offen offset:3072  lds
  s_barrier
  s_add_u32 s71, s84, 1
  s_and_b32 s71, s71, 7
  s_lshl_b32 s70, s71, 7
  s_add_u32 m0, s68, 32768
  s_add_u32 s70, s70, s66
  buffer_load_dwordx4 v2, s[4:7], s70 offen offset:0  lds
  buffer_load_dwordx4 v3, s[4:7], s70 offen offset:1024  lds
  buffer_load_dwordx4 v4, s[4:7], s70 offen offset:2048  lds
  buffer_load_dwordx4 v5, s[4:7], s70 offen offset:3072  lds
  s_mul_i32 s70, s71, 229376
  s_add_u32 m0, s68, 49152
  s_add_u32 s70, s70, s67
  buffer_load_dwordx4 v6, s[8:11], s70 offen offset:0  lds
  buffer_load_dwordx4 v7, s[8:11], s70 offen offset:1024  lds
  buffer_load_dwordx4 v8, s[8:11], s70 offen offset:2048  lds
  buffer_load_dwordx4 v9, s[8:11], s70 offen offset:3072  lds
  s_mov_b32 s16, s62
  s_and_b32 s17, s63, 0xffff
  s_mov_b32 s18, 20971520
  s_mov_b32 s19, 0x20000
  s_mov_b32 s20, s58
  s_and_b32 s21, s59, 0xffff
  s_mov_b32 s22, 2097152
  s_mov_b32 s23, 0x20000
  v_and_b32 v30, 31, v1
  v_lshrrev_b32 v31, 5, v1
  v_lshrrev_b32 v32, 1, v30
  v_and_b32 v32, 7, v32
  v_xor_b32 v32, v32, v31
  s_lshr_b32 s69, s26, 1
  s_lshl_b32 s69, s69, 13
  v_lshlrev_b32 v30, 7, v30
  v_add_u32 v30, s69, v30
  v_xor_b32 v33, 0, v32
  v_lshl_add_u32 v10, v33, 4, v30
  v_add_u32 v14, 0x10000, v10
  v_xor_b32 v33, 2, v32
  v_lshl_add_u32 v11, v33, 4, v30
  v_add_u32 v15, 0x10000, v11
  v_xor_b32 v33, 4, v32
  v_lshl_add_u32 v12, v33, 4, v30
  v_add_u32 v16, 0x10000, v12
  v_xor_b32 v33, 6, v32
  v_lshl_add_u32 v13, v33, 4, v30
  v_add_u32 v17, 0x10000, v13
  v_bfe_u32 v32, v1, 2, 2
  v_bfe_u32 v33, v1, 4, 1
  v_bfe_u32 v34, v1, 1, 1
  v_lshl_add_u32 v33, v33, 1, v34
  s_and_b32 s69, s26, 1
  s_lshl_b32 s69, s69, 3
  v_add_u32 v33, s69, v33
  v_lshlrev_b32 v34, 2, v32
  v_xor_b32 v33, v33, v34
  v_lshl_add_u32 v32, v31, 3, v32
  v_lshlrev_b32 v32, 8, v32
  v_lshl_add_u32 v32, v33, 4, v32
  v_and_b32 v34, 1, v1
  v_lshl_add_u32 v32, v34, 3, v32
  v_add_u32 v18, 16384, v32
  v_xor_b32 v19, 64, v18
  v_add_u32 v20, 0x10000, v18
  v_add_u32 v21, 0x10000, v19
  s_mov_b32 s72, 1.0
  s_mov_b32 s73, 1.0
  s_mov_b32 s74, 0xbfb8aa3b
  s_mov_b32 s75, 0xbfb8aa3b
  s_lshl_b32 s69, s26, 2
  s_add_u32 s69, s69, 162816
  v_mov_b32 v50, s69
  v_and_b32 v51, 3, v1
  v_lshlrev_b32 v51, 2, v51
  v_add_u32 v51, 162816, v51
  s_and_b32 s69, s24, 6
  s_lshl_b32 s69, s69, 1
  s_and_b32 s70, s25, 3
  s_add_u32 s69, s69, s70
  s_and_b32 s70, s24, 1
  s_lshl_b32 s32, s69, 1
  s_add_u32 s32, s32, s70
  s_lshl_b32 s32, s32, 13
  s_add_u32 s32, s32, 13041664
  v_min_u32 v30, 27, v1
  v_lshl_add_u32 v59, v30, 8, s32
  s_mov_b32 s12, s54
  s_and_b32 s13, s55, 0xffff
  s_mov_b32 s14, 1835008
  s_mov_b32 s15, 0x20000
  s_mul_i32 s82, s70, -4608
  s_add_u32 s82, s82, s32
  s_lshr_b32 s83, s26, 1
  s_lshl_b32 s83, s83, 13
  s_add_u32 s82, s82, s83
  s_and_b32 s83, s26, 1
  s_mul_i32 s83, s83, 1792
  s_add_u32 s82, s82, s83
  v_min_u32 v30, 6, v1
  v_lshl_add_u32 v59, v30, 8, s82
  s_mul_i32 s82, s26, 458752
  s_lshr_b32 s83, s25, 2
  s_lshl_b32 s83, s83, 7
  s_add_u32 s82, s82, s83
  s_lshl_b32 s83, s26, 15
  s_lshl_b32 s69, s69, 2
  s_and_b32 s81, s26, 1
  s_add_u32 s69, s69, s81
  s_lshl_b32 s76, s70, 1
  s_add_u32 s76, s76, s69
  s_xor_b32 s80, s76, 1
  s_mul_i32 s80, s80, 112
  s_mul_i32 s81, s76, 112
  s_lshl_b32 s70, s70, 1
  s_lshr_b32 s69, s26, 1
  s_add_u32 s70, s70, s69
  s_mul_i32 s70, s26, 28
  s_add_u32 s80, s80, s70
  s_add_u32 s81, s81, s70
  s_lshl_b32 s80, s80, 10
  s_lshl_b32 s81, s81, 10
  s_lshl_b32 s76, s76, 15
  s_lshr_b32 s70, s25, 2
  s_lshl_b32 s70, s70, 1
  s_add_u32 s70, s70, s69
  s_lshl_b32 s70, s70, 6
  s_add_u32 s76, s76, s70
  v_lshlrev_b32 v54, 4, v1
  s_lshl_b32 s70, s26, 15
  v_add_u32 v58, s70, v54
  v_xor_b32 v63, 0x10000, v58
  s_lshl_b32 s70, s26, 12
  s_add_u32 s70, s70, 131072
  v_add_u32 v49, s70, v54
  v_lshrrev_b32 v31, 5, v1
  v_and_b32 v30, 31, v1
  v_lshlrev_b32 v30, 10, v30
  v_lshl_add_u32 v55, v31, 4, v30
  v_bfe_u32 v32, v1, 2, 2
  v_bfe_u32 v33, v1, 4, 1
  v_bfe_u32 v34, v1, 1, 1
  v_lshl_add_u32 v33, v33, 1, v34
  v_bfe_u32 v34, v1, 3, 1
  v_xor_b32 v34, s69, v34
  v_lshl_add_u32 v33, v34, 2, v33
  v_lshl_add_u32 v32, v31, 2, v32
  v_lshlrev_b32 v32, 7, v32
  v_lshl_add_u32 v32, v33, 4, v32
  v_and_b32 v34, 1, v1
  v_lshl_add_u32 v32, v34, 3, v32
  s_lshl_b32 s69, s69, 16
  v_add_u32 v56, s83, v32
  v_xor_b32 v57, 64, v56
  s_add_u32 s71, s84, 2
  s_and_b32 s71, s71, 7
  s_lshl_b32 s70, s71, 7
  s_add_u32 m0, s68, 65536
  s_add_u32 s70, s70, s66
  buffer_load_dwordx4 v2, s[4:7], s70 offen offset:0  lds
  buffer_load_dwordx4 v3, s[4:7], s70 offen offset:1024  lds
  buffer_load_dwordx4 v4, s[4:7], s70 offen offset:2048  lds
  buffer_load_dwordx4 v5, s[4:7], s70 offen offset:3072  lds
  s_mul_i32 s70, s71, 229376
  s_add_u32 m0, s68, 81920
  s_add_u32 s70, s70, s67
  buffer_load_dwordx4 v6, s[8:11], s70 offen offset:0  lds
  buffer_load_dwordx4 v7, s[8:11], s70 offen offset:1024  lds
  buffer_load_dwordx4 v8, s[8:11], s70 offen offset:2048  lds
  buffer_load_dwordx4 v9, s[8:11], s70 offen offset:3072  lds
  s_waitcnt vmcnt(16)
  v_mov_b32 v52, 1
  ds_write_b32 v50, v52
  ds_read_b32 v53, v51 offset:0
  s_waitcnt lgkmcnt(0)
  v_cmp_gt_u32 vcc, 1, v53
  s_cbranch_vccz LWD_2
LW_1:
  ds_read_b32 v53, v51 offset:0
  s_waitcnt lgkmcnt(0)
  v_cmp_gt_u32 vcc, 1, v53
  s_cbranch_vccnz LW_1
LWD_2:
  ds_read_b64_tr_b16 v[128:129], v18 offset:0
  ds_read_b64_tr_b16 v[130:131], v18 offset:1024
  ds_read_b64_tr_b16 v[132:133], v19 offset:0
  ds_read_b64_tr_b16 v[134:135], v19 offset:1024
  ds_read_b128 v[136:139], v10 offset:0
  ds_read_b128 v[140:143], v10 offset:4096
  ds_read_b64_tr_b16 v[144:145], v18 offset:4096
  ds_read_b64_tr_b16 v[146:147], v18 offset:5120
  ds_read_b64_tr_b16 v[148:149], v19 offset:4096
  ds_read_b64_tr_b16 v[150:151], v19 offset:5120
  ds_read_b128 v[152:155], v11 offset:0
  ds_read_b128 v[156:159], v11 offset:4096
  s_waitcnt vmcnt(8)
  v_mov_b32 v52, 2
  s_waitcnt lgkmcnt(6)
  v_mfma_f32_32x32x16_bf16 v[64:79], v[128:131], v[136:139], 0
  ds_write_b32 v50, v52
  ds_read_b64_tr_b16 v[160:161], v18 offset:8192
  ds_read_b64_tr_b16 v[162:163], v18 offset:9216
  v_mfma_f32_32x32x16_bf16 v[80:95], v[128:131], v[140:143], 0
  ds_read_b64_tr_b16 v[164:165], v19 offset:8192
  ds_read_b64_tr_b16 v[166:167], v19 offset:9216
  v_mfma_f32_32x32x16_bf16 v[96:111], v[132:135], v[136:139], 0
  ds_read_b128 v[168:171], v12 offset:0
  ds_read_b128 v[172:175], v12 offset:4096
  s_add_u32 s71, s84, 3
  s_and_b32 s71, s71, 7
  s_lshl_b32 s70, s71, 7
  s_add_u32 m0, s68, 98304
  s_add_u32 s70, s70, s66
  buffer_load_dwordx4 v2, s[4:7], s70 offen offset:0  lds
  buffer_load_dwordx4 v3, s[4:7], s70 offen offset:1024  lds
  v_mfma_f32_32x32x16_bf16 v[112:127], v[132:135], v[140:143], 0
  s_waitcnt lgkmcnt(7)
  v_mfma_f32_32x32x16_bf16 v[64:79], v[144:147], v[152:155], v[64:79]
  ds_read_b32 v53, v51 offset:0
  ds_read_b64_tr_b16 v[128:129], v18 offset:12288
  ds_read_b64_tr_b16 v[130:131], v18 offset:13312
  v_mfma_f32_32x32x16_bf16 v[80:95], v[144:147], v[156:159], v[80:95]
  ds_read_b64_tr_b16 v[132:133], v19 offset:12288
  ds_read_b64_tr_b16 v[134:135], v19 offset:13312
  v_mfma_f32_32x32x16_bf16 v[96:111], v[148:151], v[152:155], v[96:111]
  ds_read_b128 v[136:139], v13 offset:0
  ds_read_b128 v[140:143], v13 offset:4096
  buffer_load_dwordx4 v4, s[4:7], s70 offen offset:2048  lds
  buffer_load_dwordx4 v5, s[4:7], s70 offen offset:3072  lds
  v_mfma_f32_32x32x16_bf16 v[112:127], v[148:151], v[156:159], v[112:127]
  s_waitcnt lgkmcnt(6)
  v_cmp_gt_u32 vcc, 2, v53
  s_cbranch_vccz LWD_4
LW_3:
  ds_read_b32 v53, v51 offset:0
  s_waitcnt lgkmcnt(0)
  v_cmp_gt_u32 vcc, 2, v53
  s_cbranch_vccnz LW_3
LWD_4:
  v_mfma_f32_32x32x16_bf16 v[64:79], v[160:163], v[168:171], v[64:79]
  ds_read_b64_tr_b16 v[144:145], v18 offset:32768
  ds_read_b64_tr_b16 v[146:147], v18 offset:33792
  v_mfma_f32_32x32x16_bf16 v[80:95], v[160:163], v[172:175], v[80:95]
  ds_read_b64_tr_b16 v[148:149], v19 offset:32768
  ds_read_b64_tr_b16 v[150:151], v19 offset:33792
  v_mfma_f32_32x32x16_bf16 v[96:111], v[164:167], v[168:171], v[96:111]
  ds_read_b128 v[152:155], v10 offset:32768
  ds_read_b128 v[156:159], v10 offset:36864
  s_mul_i32 s70, s71, 229376
  s_add_u32 m0, s68, 114688
  s_add_u32 s70, s70, s67
  buffer_load_dwordx4 v6, s[8:11], s70 offen offset:0  lds
  buffer_load_dwordx4 v7, s[8:11], s70 offen offset:1024  lds
  v_mfma_f32_32x32x16_bf16 v[112:127], v[164:167], v[172:175], v[112:127]
  s_waitcnt lgkmcnt(6)
  v_mfma_f32_32x32x16_bf16 v[64:79], v[128:131], v[136:139], v[64:79]
  v_mov_b32 v52, 1
  ds_write_b32 v50, v52 offset:16
  ds_read_b64_tr_b16 v[160:161], v18 offset:36864
  ds_read_b64_tr_b16 v[162:163], v18 offset:37888
  v_mfma_f32_32x32x16_bf16 v[80:95], v[128:131], v[140:143], v[80:95]
  ds_read_b64_tr_b16 v[164:165], v19 offset:36864
  ds_read_b64_tr_b16 v[166:167], v19 offset:37888
  v_mfma_f32_32x32x16_bf16 v[96:111], v[132:135], v[136:139], v[96:111]
  ds_read_b128 v[168:171], v11 offset:32768
  ds_read_b128 v[172:175], v11 offset:36864
  buffer_load_dwordx4 v8, s[8:11], s70 offen offset:2048  lds
  buffer_load_dwordx4 v9, s[8:11], s70 offen offset:3072  lds
  v_mfma_f32_32x32x16_bf16 v[112:127], v[132:135], v[140:143], v[112:127]
  s_waitcnt vmcnt(8)
  v_mov_b32 v52, 3
  s_waitcnt lgkmcnt(7)
  v_mfma_f32_32x32x16_bf16 v[64:79], v[144:147], v[152:155], v[64:79]
  ds_write_b32 v50, v52
  ds_read_b64_tr_b16 v[128:129], v18 offset:40960
  ds_read_b64_tr_b16 v[130:131], v18 offset:41984
  v_mfma_f32_32x32x16_bf16 v[80:95], v[144:147], v[156:159], v[80:95]
  ds_read_b64_tr_b16 v[132:133], v19 offset:40960
  ds_read_b64_tr_b16 v[134:135], v19 offset:41984
  v_mfma_f32_32x32x16_bf16 v[96:111], v[148:151], v[152:155], v[96:111]
  ds_read_b128 v[136:139], v12 offset:32768
  ds_read_b128 v[140:143], v12 offset:36864
  v_mfma_f32_32x32x16_bf16 v[112:127], v[148:151], v[156:159], v[112:127]
  s_waitcnt lgkmcnt(7)
  v_mfma_f32_32x32x16_bf16 v[64:79], v[160:163], v[168:171], v[64:79]
  ds_read_b32 v53, v51 offset:0
  ds_read_b64_tr_b16 v[144:145], v18 offset:45056
  ds_read_b64_tr_b16 v[146:147], v18 offset:46080
  v_mfma_f32_32x32x16_bf16 v[80:95], v[160:163], v[172:175], v[80:95]
  ds_read_b64_tr_b16 v[148:149], v19 offset:45056
  ds_read_b64_tr_b16 v[150:151], v19 offset:46080
  v_mfma_f32_32x32x16_bf16 v[96:111], v[164:167], v[168:171], v[96:111]
  ds_read_b128 v[152:155], v13 offset:32768
  ds_read_b128 v[156:159], v13 offset:36864
  v_mfma_f32_32x32x16_bf16 v[112:127], v[164:167], v[172:175], v[112:127]
  s_waitcnt lgkmcnt(6)
  v_cmp_gt_u32 vcc, 3, v53
  s_cbranch_vccz LWD_6
LW_5:
  ds_read_b32 v53, v51 offset:0
  s_waitcnt lgkmcnt(0)
  v_cmp_gt_u32 vcc, 3, v53
  s_cbranch_vccnz LW_5
LWD_6:
  v_mfma_f32_32x32x16_bf16 v[64:79], v[128:131], v[136:139], v[64:79]
  ds_read_b64_tr_b16 v[160:161], v20 offset:0
  ds_read_b64_tr_b16 v[162:163], v20 offset:1024
  v_mfma_f32_32x32x16_bf16 v[80:95], v[128:131], v[140:143], v[80:95]
  ds_read_b64_tr_b16 v[164:165], v21 offset:0
  ds_read_b64_tr_b16 v[166:167], v21 offset:1024
  v_mfma_f32_32x32x16_bf16 v[96:111], v[132:135], v[136:139], v[96:111]
  ds_read_b128 v[168:171], v14 offset:0
  ds_read_b128 v[172:175], v14 offset:4096
  v_mfma_f32_32x32x16_bf16 v[112:127], v[132:135], v[140:143], v[112:127]
  s_waitcnt lgkmcnt(6)
  v_mfma_f32_32x32x16_bf16 v[64:79], v[144:147], v[152:155], v[64:79]
  v_mov_b32 v52, 2
  ds_write_b32 v50, v52 offset:16
  ds_read_b64_tr_b16 v[128:129], v20 offset:4096
  ds_read_b64_tr_b16 v[130:131], v20 offset:5120
  v_mfma_f32_32x32x16_bf16 v[80:95], v[144:147], v[156:159], v[80:95]
  ds_read_b64_tr_b16 v[132:133], v21 offset:4096
  ds_read_b64_tr_b16 v[134:135], v21 offset:5120
  v_mfma_f32_32x32x16_bf16 v[96:111], v[148:151], v[152:155], v[96:111]
  ds_read_b128 v[136:139], v15 offset:0
  ds_read_b128 v[140:143], v15 offset:4096
  v_mfma_f32_32x32x16_bf16 v[112:127], v[148:151], v[156:159], v[112:127]
  s_waitcnt vmcnt(0)
  v_mov_b32 v52, 4
  s_waitcnt lgkmcnt(7)
  v_mfma_f32_32x32x16_bf16 v[64:79], v[160:163], v[168:171], v[64:79]
  ds_write_b32 v50, v52
  ds_read_b64_tr_b16 v[144:145], v20 offset:8192
  ds_read_b64_tr_b16 v[146:147], v20 offset:9216
  v_mfma_f32_32x32x16_bf16 v[80:95], v[160:163], v[172:175], v[80:95]
  ds_read_b64_tr_b16 v[148:149], v21 offset:8192
  ds_read_b64_tr_b16 v[150:151], v21 offset:9216
  v_mfma_f32_32x32x16_bf16 v[96:111], v[164:167], v[168:171], v[96:111]
  ds_read_b128 v[152:155], v16 offset:0
  ds_read_b128 v[156:159], v16 offset:4096
  v_mfma_f32_32x32x16_bf16 v[112:127], v[164:167], v[172:175], v[112:127]
  s_waitcnt lgkmcnt(7)
  v_mfma_f32_32x32x16_bf16 v[64:79], v[128:131], v[136:139], v[64:79]
  ds_read_b32 v53, v51 offset:0
  ds_read_b64_tr_b16 v[160:161], v20 offset:12288
  ds_read_b64_tr_b16 v[162:163], v20 offset:13312
  v_mfma_f32_32x32x16_bf16 v[80:95], v[128:131], v[140:143], v[80:95]
  ds_read_b64_tr_b16 v[164:165], v21 offset:12288
  ds_read_b64_tr_b16 v[166:167], v21 offset:13312
  v_mfma_f32_32x32x16_bf16 v[96:111], v[132:135], v[136:139], v[96:111]
  ds_read_b128 v[168:171], v17 offset:0
  ds_read_b128 v[172:175], v17 offset:4096
  v_mfma_f32_32x32x16_bf16 v[112:127], v[132:135], v[140:143], v[112:127]
  s_waitcnt lgkmcnt(6)
  v_cmp_gt_u32 vcc, 4, v53
  s_cbranch_vccz LWD_8
LW_7:
  ds_read_b32 v53, v51 offset:0
  s_waitcnt lgkmcnt(0)
  v_cmp_gt_u32 vcc, 4, v53
  s_cbranch_vccnz LW_7
LWD_8:
  v_mfma_f32_32x32x16_bf16 v[64:79], v[144:147], v[152:155], v[64:79]
  ds_read_b64_tr_b16 v[128:129], v20 offset:32768
  ds_read_b64_tr_b16 v[130:131], v20 offset:33792
  v_mfma_f32_32x32x16_bf16 v[80:95], v[144:147], v[156:159], v[80:95]
  ds_read_b64_tr_b16 v[132:133], v21 offset:32768
  ds_read_b64_tr_b16 v[134:135], v21 offset:33792
  v_mfma_f32_32x32x16_bf16 v[96:111], v[148:151], v[152:155], v[96:111]
  ds_read_b128 v[136:139], v14 offset:32768
  ds_read_b128 v[140:143], v14 offset:36864
  v_mfma_f32_32x32x16_bf16 v[112:127], v[148:151], v[156:159], v[112:127]
  s_waitcnt lgkmcnt(6)
  v_mfma_f32_32x32x16_bf16 v[64:79], v[160:163], v[168:171], v[64:79]
  v_mov_b32 v52, 3
  ds_write_b32 v50, v52 offset:16
  ds_read_b64_tr_b16 v[144:145], v20 offset:36864
  ds_read_b64_tr_b16 v[146:147], v20 offset:37888
  v_mfma_f32_32x32x16_bf16 v[80:95], v[160:163], v[172:175], v[80:95]
  ds_read_b64_tr_b16 v[148:149], v21 offset:36864
  ds_read_b64_tr_b16 v[150:151], v21 offset:37888
  v_mfma_f32_32x32x16_bf16 v[96:111], v[164:167], v[168:171], v[96:111]
  ds_read_b128 v[152:155], v15 offset:32768
  ds_read_b128 v[156:159], v15 offset:36864
  v_mfma_f32_32x32x16_bf16 v[112:127], v[164:167], v[172:175], v[112:127]
  s_waitcnt lgkmcnt(7)
  v_mfma_f32_32x32x16_bf16 v[64:79], v[128:131], v[136:139], v[64:79]
  ds_read_b64_tr_b16 v[160:161], v20 offset:40960
  ds_read_b64_tr_b16 v[162:163], v20 offset:41984
  v_mfma_f32_32x32x16_bf16 v[80:95], v[128:131], v[140:143], v[80:95]
  ds_read_b64_tr_b16 v[164:165], v21 offset:40960
  ds_read_b64_tr_b16 v[166:167], v21 offset:41984
  v_mfma_f32_32x32x16_bf16 v[96:111], v[132:135], v[136:139], v[96:111]
  ds_read_b128 v[168:171], v16 offset:32768
  ds_read_b128 v[172:175], v16 offset:36864
  v_mfma_f32_32x32x16_bf16 v[112:127], v[132:135], v[140:143], v[112:127]
  s_waitcnt lgkmcnt(6)
  v_mfma_f32_32x32x16_bf16 v[64:79], v[144:147], v[152:155], v[64:79]
  ds_read_b32 v53, v51 offset:48
  ds_read_b64_tr_b16 v[128:129], v20 offset:45056
  ds_read_b64_tr_b16 v[130:131], v20 offset:46080
  v_mfma_f32_32x32x16_bf16 v[80:95], v[144:147], v[156:159], v[80:95]
  ds_read_b64_tr_b16 v[132:133], v21 offset:45056
  ds_read_b64_tr_b16 v[134:135], v21 offset:46080
  v_mfma_f32_32x32x16_bf16 v[96:111], v[148:151], v[152:155], v[96:111]
  ds_read_b128 v[136:139], v17 offset:32768
  ds_read_b128 v[140:143], v17 offset:36864
  v_mfma_f32_32x32x16_bf16 v[112:127], v[148:151], v[156:159], v[112:127]
  s_waitcnt lgkmcnt(6)
  v_cmp_gt_u32 vcc, 5, v53
  s_cbranch_vccz LWD_10
LW_9:
  ds_read_b32 v53, v51 offset:48
  s_waitcnt lgkmcnt(0)
  v_cmp_gt_u32 vcc, 5, v53
  s_cbranch_vccnz LW_9
LWD_10:
  v_mfma_f32_32x32x16_bf16 v[64:79], v[160:163], v[168:171], v[64:79]
  ds_read_b64_tr_b16 v[144:145], v18 offset:0
  ds_read_b64_tr_b16 v[146:147], v18 offset:1024
  v_mfma_f32_32x32x16_bf16 v[80:95], v[160:163], v[172:175], v[80:95]
  ds_read_b64_tr_b16 v[148:149], v19 offset:0
  ds_read_b64_tr_b16 v[150:151], v19 offset:1024
  v_mfma_f32_32x32x16_bf16 v[96:111], v[164:167], v[168:171], v[96:111]
  ds_read_b128 v[152:155], v10 offset:0
  ds_read_b128 v[156:159], v10 offset:4096
  v_mfma_f32_32x32x16_bf16 v[112:127], v[164:167], v[172:175], v[112:127]
  s_waitcnt lgkmcnt(6)
  v_mfma_f32_32x32x16_bf16 v[64:79], v[128:131], v[136:139], v[64:79]
  v_mov_b32 v52, 4
  ds_write_b32 v50, v52 offset:16
  ds_read_b64_tr_b16 v[160:161], v18 offset:4096
  ds_read_b64_tr_b16 v[162:163], v18 offset:5120
  v_mfma_f32_32x32x16_bf16 v[80:95], v[128:131], v[140:143], v[80:95]
  ds_read_b64_tr_b16 v[164:165], v19 offset:4096
  ds_read_b64_tr_b16 v[166:167], v19 offset:5120
  v_mfma_f32_32x32x16_bf16 v[96:111], v[132:135], v[136:139], v[96:111]
  ds_read_b128 v[168:171], v11 offset:0
  ds_read_b128 v[172:175], v11 offset:4096
  v_mfma_f32_32x32x16_bf16 v[112:127], v[132:135], v[140:143], v[112:127]
  s_waitcnt lgkmcnt(7)
  v_mfma_f32_32x32x16_bf16 v[64:79], v[144:147], v[152:155], v[64:79]
  ds_read_b64_tr_b16 v[128:129], v18 offset:8192
  ds_read_b64_tr_b16 v[130:131], v18 offset:9216
  v_mfma_f32_32x32x16_bf16 v[80:95], v[144:147], v[156:159], v[80:95]
  ds_read_b64_tr_b16 v[132:133], v19 offset:8192
  ds_read_b64_tr_b16 v[134:135], v19 offset:9216
  v_mfma_f32_32x32x16_bf16 v[96:111], v[148:151], v[152:155], v[96:111]
  ds_read_b128 v[136:139], v12 offset:0
  ds_read_b128 v[140:143], v12 offset:4096
  v_mfma_f32_32x32x16_bf16 v[112:127], v[148:151], v[156:159], v[112:127]
  s_waitcnt lgkmcnt(6)
  v_mfma_f32_32x32x16_bf16 v[64:79], v[160:163], v[168:171], v[64:79]
  ds_read_b32 v53, v51 offset:48
  ds_read_b64_tr_b16 v[144:145], v18 offset:12288
  ds_read_b64_tr_b16 v[146:147], v18 offset:13312
  v_mfma_f32_32x32x16_bf16 v[80:95], v[160:163], v[172:175], v[80:95]
  ds_read_b64_tr_b16 v[148:149], v19 offset:12288
  ds_read_b64_tr_b16 v[150:151], v19 offset:13312
  v_mfma_f32_32x32x16_bf16 v[96:111], v[164:167], v[168:171], v[96:111]
  ds_read_b128 v[152:155], v13 offset:0
  ds_read_b128 v[156:159], v13 offset:4096
  v_mfma_f32_32x32x16_bf16 v[112:127], v[164:167], v[172:175], v[112:127]
  s_waitcnt lgkmcnt(6)
  v_cmp_gt_u32 vcc, 6, v53
  s_cbranch_vccz LWD_12
LW_11:
  ds_read_b32 v53, v51 offset:48
  s_waitcnt lgkmcnt(0)
  v_cmp_gt_u32 vcc, 6, v53
  s_cbranch_vccnz LW_11
LWD_12:
  v_mfma_f32_32x32x16_bf16 v[64:79], v[128:131], v[136:139], v[64:79]
  ds_read_b64_tr_b16 v[160:161], v18 offset:32768
  ds_read_b64_tr_b16 v[162:163], v18 offset:33792
  v_mfma_f32_32x32x16_bf16 v[80:95], v[128:131], v[140:143], v[80:95]
  ds_read_b64_tr_b16 v[164:165], v19 offset:32768
  ds_read_b64_tr_b16 v[166:167], v19 offset:33792
  v_mfma_f32_32x32x16_bf16 v[96:111], v[132:135], v[136:139], v[96:111]
  ds_read_b128 v[168:171], v10 offset:32768
  ds_read_b128 v[172:175], v10 offset:36864
  v_mfma_f32_32x32x16_bf16 v[112:127], v[132:135], v[140:143], v[112:127]
  s_waitcnt lgkmcnt(6)
  v_mfma_f32_32x32x16_bf16 v[64:79], v[144:147], v[152:155], v[64:79]
  v_mov_b32 v52, 5
  ds_write_b32 v50, v52 offset:16
  ds_read_b64_tr_b16 v[128:129], v18 offset:36864
  ds_read_b64_tr_b16 v[130:131], v18 offset:37888
  v_mfma_f32_32x32x16_bf16 v[80:95], v[144:147], v[156:159], v[80:95]
  ds_read_b64_tr_b16 v[132:133], v19 offset:36864
  ds_read_b64_tr_b16 v[134:135], v19 offset:37888
  v_mfma_f32_32x32x16_bf16 v[96:111], v[148:151], v[152:155], v[96:111]
  ds_read_b128 v[136:139], v11 offset:32768
  ds_read_b128 v[140:143], v11 offset:36864
  v_mfma_f32_32x32x16_bf16 v[112:127], v[148:151], v[156:159], v[112:127]
  s_waitcnt lgkmcnt(7)
  v_mfma_f32_32x32x16_bf16 v[64:79], v[160:163], v[168:171], v[64:79]
  ds_read_b64_tr_b16 v[144:145], v18 offset:40960
  ds_read_b64_tr_b16 v[146:147], v18 offset:41984
  v_mfma_f32_32x32x16_bf16 v[80:95], v[160:163], v[172:175], v[80:95]
  ds_read_b64_tr_b16 v[148:149], v19 offset:40960
  ds_read_b64_tr_b16 v[150:151], v19 offset:41984
  v_mfma_f32_32x32x16_bf16 v[96:111], v[164:167], v[168:171], v[96:111]
  ds_read_b128 v[152:155], v12 offset:32768
  ds_read_b128 v[156:159], v12 offset:36864
  v_mfma_f32_32x32x16_bf16 v[112:127], v[164:167], v[172:175], v[112:127]
  s_waitcnt lgkmcnt(6)
  v_mfma_f32_32x32x16_bf16 v[64:79], v[128:131], v[136:139], v[64:79]
  ds_read_b32 v53, v51 offset:48
  ds_read_b64_tr_b16 v[160:161], v18 offset:45056
  ds_read_b64_tr_b16 v[162:163], v18 offset:46080
  v_mfma_f32_32x32x16_bf16 v[80:95], v[128:131], v[140:143], v[80:95]
  ds_read_b64_tr_b16 v[164:165], v19 offset:45056
  ds_read_b64_tr_b16 v[166:167], v19 offset:46080
  v_mfma_f32_32x32x16_bf16 v[96:111], v[132:135], v[136:139], v[96:111]
  ds_read_b128 v[168:171], v13 offset:32768
  ds_read_b128 v[172:175], v13 offset:36864
  v_mfma_f32_32x32x16_bf16 v[112:127], v[132:135], v[140:143], v[112:127]
  s_waitcnt lgkmcnt(6)
  v_cmp_gt_u32 vcc, 7, v53
  s_cbranch_vccz LWD_14
LW_13:
  ds_read_b32 v53, v51 offset:48
  s_waitcnt lgkmcnt(0)
  v_cmp_gt_u32 vcc, 7, v53
  s_cbranch_vccnz LW_13
LWD_14:
  v_mfma_f32_32x32x16_bf16 v[64:79], v[144:147], v[152:155], v[64:79]
  ds_read_b64_tr_b16 v[128:129], v20 offset:0
  ds_read_b64_tr_b16 v[130:131], v20 offset:1024
  v_mfma_f32_32x32x16_bf16 v[80:95], v[144:147], v[156:159], v[80:95]
  ds_read_b64_tr_b16 v[132:133], v21 offset:0
  ds_read_b64_tr_b16 v[134:135], v21 offset:1024
  v_mfma_f32_32x32x16_bf16 v[96:111], v[148:151], v[152:155], v[96:111]
  ds_read_b128 v[136:139], v14 offset:0
  ds_read_b128 v[140:143], v14 offset:4096
  v_mfma_f32_32x32x16_bf16 v[112:127], v[148:151], v[156:159], v[112:127]
  s_waitcnt lgkmcnt(6)
  v_mfma_f32_32x32x16_bf16 v[64:79], v[160:163], v[168:171], v[64:79]
  v_mov_b32 v52, 6
  ds_write_b32 v50, v52 offset:16
  ds_read_b64_tr_b16 v[144:145], v20 offset:4096
  ds_read_b64_tr_b16 v[146:147], v20 offset:5120
  v_mfma_f32_32x32x16_bf16 v[80:95], v[160:163], v[172:175], v[80:95]
  ds_read_b64_tr_b16 v[148:149], v21 offset:4096
  ds_read_b64_tr_b16 v[150:151], v21 offset:5120
  v_mfma_f32_32x32x16_bf16 v[96:111], v[164:167], v[168:171], v[96:111]
  ds_read_b128 v[152:155], v15 offset:0
  ds_read_b128 v[156:159], v15 offset:4096
  v_mfma_f32_32x32x16_bf16 v[112:127], v[164:167], v[172:175], v[112:127]
  s_waitcnt lgkmcnt(7)
  v_mfma_f32_32x32x16_bf16 v[64:79], v[128:131], v[136:139], v[64:79]
  ds_read_b64_tr_b16 v[160:161], v20 offset:8192
  ds_read_b64_tr_b16 v[162:163], v20 offset:9216
  v_mfma_f32_32x32x16_bf16 v[80:95], v[128:131], v[140:143], v[80:95]
  ds_read_b64_tr_b16 v[164:165], v21 offset:8192
  ds_read_b64_tr_b16 v[166:167], v21 offset:9216
  v_mfma_f32_32x32x16_bf16 v[96:111], v[132:135], v[136:139], v[96:111]
  ds_read_b128 v[168:171], v16 offset:0
  ds_read_b128 v[172:175], v16 offset:4096
  v_mfma_f32_32x32x16_bf16 v[112:127], v[132:135], v[140:143], v[112:127]
  s_waitcnt lgkmcnt(6)
  v_mfma_f32_32x32x16_bf16 v[64:79], v[144:147], v[152:155], v[64:79]
  ds_read_b32 v53, v51 offset:48
  ds_read_b64_tr_b16 v[128:129], v20 offset:12288
  ds_read_b64_tr_b16 v[130:131], v20 offset:13312
  v_mfma_f32_32x32x16_bf16 v[80:95], v[144:147], v[156:159], v[80:95]
  ds_read_b64_tr_b16 v[132:133], v21 offset:12288
  ds_read_b64_tr_b16 v[134:135], v21 offset:13312
  v_mfma_f32_32x32x16_bf16 v[96:111], v[148:151], v[152:155], v[96:111]
  ds_read_b128 v[136:139], v17 offset:0
  ds_read_b128 v[140:143], v17 offset:4096
  v_mfma_f32_32x32x16_bf16 v[112:127], v[148:151], v[156:159], v[112:127]
  s_waitcnt lgkmcnt(6)
  v_cmp_gt_u32 vcc, 8, v53
  s_cbranch_vccz LWD_16
LW_15:
  ds_read_b32 v53, v51 offset:48
  s_waitcnt lgkmcnt(0)
  v_cmp_gt_u32 vcc, 8, v53
  s_cbranch_vccnz LW_15
LWD_16:
  v_mfma_f32_32x32x16_bf16 v[64:79], v[160:163], v[168:171], v[64:79]
  ds_read_b64_tr_b16 v[144:145], v20 offset:32768
  ds_read_b64_tr_b16 v[146:147], v20 offset:33792
  v_mfma_f32_32x32x16_bf16 v[80:95], v[160:163], v[172:175], v[80:95]
  ds_read_b64_tr_b16 v[148:149], v21 offset:32768
  ds_read_b64_tr_b16 v[150:151], v21 offset:33792
  v_mfma_f32_32x32x16_bf16 v[96:111], v[164:167], v[168:171], v[96:111]
  ds_read_b128 v[152:155], v14 offset:32768
  ds_read_b128 v[156:159], v14 offset:36864
  v_mfma_f32_32x32x16_bf16 v[112:127], v[164:167], v[172:175], v[112:127]
  s_waitcnt lgkmcnt(6)
  v_mfma_f32_32x32x16_bf16 v[64:79], v[128:131], v[136:139], v[64:79]
  v_mov_b32 v52, 7
  ds_write_b32 v50, v52 offset:16
  ds_read_b64_tr_b16 v[160:161], v20 offset:36864
  ds_read_b64_tr_b16 v[162:163], v20 offset:37888
  v_mfma_f32_32x32x16_bf16 v[80:95], v[128:131], v[140:143], v[80:95]
  ds_read_b64_tr_b16 v[164:165], v21 offset:36864
  ds_read_b64_tr_b16 v[166:167], v21 offset:37888
  v_mfma_f32_32x32x16_bf16 v[96:111], v[132:135], v[136:139], v[96:111]
  ds_read_b128 v[168:171], v15 offset:32768
  ds_read_b128 v[172:175], v15 offset:36864
  v_mfma_f32_32x32x16_bf16 v[112:127], v[132:135], v[140:143], v[112:127]
  s_waitcnt lgkmcnt(7)
  v_mfma_f32_32x32x16_bf16 v[64:79], v[144:147], v[152:155], v[64:79]
  ds_read_b64_tr_b16 v[128:129], v20 offset:40960
  ds_read_b64_tr_b16 v[130:131], v20 offset:41984
  v_mfma_f32_32x32x16_bf16 v[80:95], v[144:147], v[156:159], v[80:95]
  ds_read_b64_tr_b16 v[132:133], v21 offset:40960
  ds_read_b64_tr_b16 v[134:135], v21 offset:41984
  v_mfma_f32_32x32x16_bf16 v[96:111], v[148:151], v[152:155], v[96:111]
  ds_read_b128 v[136:139], v16 offset:32768
  ds_read_b128 v[140:143], v16 offset:36864
  v_mfma_f32_32x32x16_bf16 v[112:127], v[148:151], v[156:159], v[112:127]
  s_waitcnt lgkmcnt(6)
  v_mfma_f32_32x32x16_bf16 v[64:79], v[160:163], v[168:171], v[64:79]
  ds_read_b64_tr_b16 v[144:145], v20 offset:45056
  ds_read_b64_tr_b16 v[146:147], v20 offset:46080
  v_mfma_f32_32x32x16_bf16 v[80:95], v[160:163], v[172:175], v[80:95]
  ds_read_b64_tr_b16 v[148:149], v21 offset:45056
  ds_read_b64_tr_b16 v[150:151], v21 offset:46080
  v_mfma_f32_32x32x16_bf16 v[96:111], v[164:167], v[168:171], v[96:111]
  ds_read_b128 v[152:155], v17 offset:32768
  ds_read_b128 v[156:159], v17 offset:36864
  v_mfma_f32_32x32x16_bf16 v[112:127], v[164:167], v[172:175], v[112:127]
  s_waitcnt lgkmcnt(6)
  v_mfma_f32_32x32x16_bf16 v[64:79], v[128:131], v[136:139], v[64:79]
  v_mfma_f32_32x32x16_bf16 v[80:95], v[128:131], v[140:143], v[80:95]
  v_mfma_f32_32x32x16_bf16 v[96:111], v[132:135], v[136:139], v[96:111]
  v_mfma_f32_32x32x16_bf16 v[112:127], v[132:135], v[140:143], v[112:127]
  s_waitcnt lgkmcnt(0)
  v_mfma_f32_32x32x16_bf16 v[64:79], v[144:147], v[152:155], v[64:79]
  v_mov_b32 v52, 8
  ds_write_b32 v50, v52 offset:16
  v_mfma_f32_32x32x16_bf16 v[80:95], v[144:147], v[156:159], v[80:95]
  v_mfma_f32_32x32x16_bf16 v[96:111], v[148:151], v[152:155], v[96:111]
  v_mfma_f32_32x32x16_bf16 v[112:127], v[148:151], v[156:159], v[112:127]
  s_lshl_b32 s71, s64, 2
  s_and_b32 s69, s26, 2
  s_add_u32 s71, s71, s69
  s_mul_i32 s70, s69, 7
  s_mul_i32 s71, s71, 112
  s_lshl_b32 s69, s65, 3
  s_add_u32 s71, s71, s69
  s_and_b32 s69, s26, 1
  s_add_u32 s70, s70, s69
  s_lshl_b32 s69, s69, 2
  s_add_u32 s71, s71, s69
  s_lshr_b32 s69, s25, 2
  s_lshl_b32 s69, s69, 1
  s_add_u32 s70, s70, s69
  s_lshl_b32 s70, s70, 8
  s_add_u32 s32, s32, s70
  s_lshl_b32 s71, s71, 10
  s_add_u32 s66, s71, 114688
  v_mul_f32 v160, s74, v64
  v_mul_f32 v161, s74, v65
  v_mul_f32 v162, s74, v66
  v_mul_f32 v163, s74, v67
  v_mul_f32 v164, s74, v68
  v_mul_f32 v165, s74, v69
  v_mul_f32 v166, s74, v70
  v_mul_f32 v167, s74, v71
  v_exp_f32 v160, v160
  v_exp_f32 v161, v161
  v_exp_f32 v162, v162
  v_exp_f32 v163, v163
  v_exp_f32 v164, v164
  v_exp_f32 v165, v165
  v_exp_f32 v166, v166
  v_exp_f32 v167, v167
  v_add_f32 v160, 1.0, v160
  v_add_f32 v161, 1.0, v161
  v_add_f32 v162, 1.0, v162
  v_add_f32 v163, 1.0, v163
  v_add_f32 v164, 1.0, v164
  v_add_f32 v165, 1.0, v165
  v_add_f32 v166, 1.0, v166
  v_add_f32 v167, 1.0, v167
  v_rcp_f32 v160, v160
  v_rcp_f32 v161, v161
  v_rcp_f32 v162, v162
  v_rcp_f32 v163, v163
  v_rcp_f32 v164, v164
  v_rcp_f32 v165, v165
  v_rcp_f32 v166, v166
  v_rcp_f32 v167, v167
  v_mul_f32 v160, v160, v64
  v_mul_f32 v161, v161, v65
  v_mul_f32 v162, v162, v66
  v_mul_f32 v163, v163, v67
  v_mul_f32 v164, v164, v68
  v_mul_f32 v165, v165, v69
  v_mul_f32 v166, v166, v70
  v_mul_f32 v167, v167, v71
  v_cvt_pk_bf16_f32 v128, v160, v161
  v_cvt_pk_bf16_f32 v129, v162, v163
  v_cvt_pk_bf16_f32 v130, v164, v165
  v_cvt_pk_bf16_f32 v131, v166, v167
  buffer_store_dwordx4 v[128:131], v54, s[16:19], s71 offen offset:0 sc1
  v_mul_f32 v160, s74, v72
  v_mul_f32 v161, s74, v73
  v_mul_f32 v162, s74, v74
  v_mul_f32 v163, s74, v75
  v_mul_f32 v164, s74, v76
  v_mul_f32 v165, s74, v77
  v_mul_f32 v166, s74, v78
  v_mul_f32 v167, s74, v79
  v_exp_f32 v160, v160
  v_exp_f32 v161, v161
  v_exp_f32 v162, v162
  v_exp_f32 v163, v163
  v_exp_f32 v164, v164
  v_exp_f32 v165, v165
  v_exp_f32 v166, v166
  v_exp_f32 v167, v167
  v_add_f32 v160, 1.0, v160
  v_add_f32 v161, 1.0, v161
  v_add_f32 v162, 1.0, v162
  v_add_f32 v163, 1.0, v163
  v_add_f32 v164, 1.0, v164
  v_add_f32 v165, 1.0, v165
  v_add_f32 v166, 1.0, v166
  v_add_f32 v167, 1.0, v167
  v_rcp_f32 v160, v160
  v_rcp_f32 v161, v161
  v_rcp_f32 v162, v162
  v_rcp_f32 v163, v163
  v_rcp_f32 v164, v164
  v_rcp_f32 v165, v165
  v_rcp_f32 v166, v166
  v_rcp_f32 v167, v167
  v_mul_f32 v160, v160, v72
  v_mul_f32 v161, v161, v73
  v_mul_f32 v162, v162, v74
  v_mul_f32 v163, v163, v75
  v_mul_f32 v164, v164, v76
  v_mul_f32 v165, v165, v77
  v_mul_f32 v166, v166, v78
  v_mul_f32 v167, v167, v79
  v_cvt_pk_bf16_f32 v132, v160, v161
  v_cvt_pk_bf16_f32 v133, v162, v163
  v_cvt_pk_bf16_f32 v134, v164, v165
  v_cvt_pk_bf16_f32 v135, v166, v167
  buffer_store_dwordx4 v[132:135], v54, s[16:19], s71 offen offset:1024 sc1
  v_mul_f32 v160, s74, v80
  v_mul_f32 v161, s74, v81
  v_mul_f32 v162, s74, v82
  v_mul_f32 v163, s74, v83
  v_mul_f32 v164, s74, v84
  v_mul_f32 v165, s74, v85
  v_mul_f32 v166, s74, v86
  v_mul_f32 v167, s74, v87
  v_exp_f32 v160, v160
  v_exp_f32 v161, v161
  v_exp_f32 v162, v162
  v_exp_f32 v163, v163
  v_exp_f32 v164, v164
  v_exp_f32 v165, v165
  v_exp_f32 v166, v166
  v_exp_f32 v167, v167
  v_add_f32 v160, 1.0, v160
  v_add_f32 v161, 1.0, v161
  v_add_f32 v162, 1.0, v162
  v_add_f32 v163, 1.0, v163
  v_add_f32 v164, 1.0, v164
  v_add_f32 v165, 1.0, v165
  v_add_f32 v166, 1.0, v166
  v_add_f32 v167, 1.0, v167
  v_rcp_f32 v160, v160
  v_rcp_f32 v161, v161
  v_rcp_f32 v162, v162
  v_rcp_f32 v163, v163
  v_rcp_f32 v164, v164
  v_rcp_f32 v165, v165
  v_rcp_f32 v166, v166
  v_rcp_f32 v167, v167
  v_mul_f32 v160, v160, v80
  v_mul_f32 v161, v161, v81
  v_mul_f32 v162, v162, v82
  v_mul_f32 v163, v163, v83
  v_mul_f32 v164, v164, v84
  v_mul_f32 v165, v165, v85
  v_mul_f32 v166, v166, v86
  v_mul_f32 v167, v167, v87
  v_cvt_pk_bf16_f32 v136, v160, v161
  v_cvt_pk_bf16_f32 v137, v162, v163
  v_cvt_pk_bf16_f32 v138, v164, v165
  v_cvt_pk_bf16_f32 v139, v166, v167
  buffer_store_dwordx4 v[136:139], v54, s[16:19], s66 offen offset:0 sc1
  v_mul_f32 v160, s74, v88
  v_mul_f32 v161, s74, v89
  v_mul_f32 v162, s74, v90
  v_mul_f32 v163, s74, v91
  v_mul_f32 v164, s74, v92
  v_mul_f32 v165, s74, v93
  v_mul_f32 v166, s74, v94
  v_mul_f32 v167, s74, v95
  v_exp_f32 v160, v160
  v_exp_f32 v161, v161
  v_exp_f32 v162, v162
  v_exp_f32 v163, v163
  v_exp_f32 v164, v164
  v_exp_f32 v165, v165
  v_exp_f32 v166, v166
  v_exp_f32 v167, v167
  v_add_f32 v160, 1.0, v160
  v_add_f32 v161, 1.0, v161
  v_add_f32 v162, 1.0, v162
  v_add_f32 v163, 1.0, v163
  v_add_f32 v164, 1.0, v164
  v_add_f32 v165, 1.0, v165
  v_add_f32 v166, 1.0, v166
  v_add_f32 v167, 1.0, v167
  v_rcp_f32 v160, v160
  v_rcp_f32 v161, v161
  v_rcp_f32 v162, v162
  v_rcp_f32 v163, v163
  v_rcp_f32 v164, v164
  v_rcp_f32 v165, v165
  v_rcp_f32 v166, v166
  v_rcp_f32 v167, v167
  v_mul_f32 v160, v160, v88
  v_mul_f32 v161, v161, v89
  v_mul_f32 v162, v162, v90
  v_mul_f32 v163, v163, v91
  v_mul_f32 v164, v164, v92
  v_mul_f32 v165, v165, v93
  v_mul_f32 v166, v166, v94
  v_mul_f32 v167, v167, v95
  v_cvt_pk_bf16_f32 v140, v160, v161
  v_cvt_pk_bf16_f32 v141, v162, v163
  v_cvt_pk_bf16_f32 v142, v164, v165
  v_cvt_pk_bf16_f32 v143, v166, v167
  buffer_store_dwordx4 v[140:143], v54, s[16:19], s66 offen offset:1024 sc1
  v_mul_f32 v160, s74, v96
  v_mul_f32 v161, s74, v97
  v_mul_f32 v162, s74, v98
  v_mul_f32 v163, s74, v99
  v_mul_f32 v164, s74, v100
  v_mul_f32 v165, s74, v101
  v_mul_f32 v166, s74, v102
  v_mul_f32 v167, s74, v103
  v_exp_f32 v160, v160
  v_exp_f32 v161, v161
  v_exp_f32 v162, v162
  v_exp_f32 v163, v163
  v_exp_f32 v164, v164
  v_exp_f32 v165, v165
  v_exp_f32 v166, v166
  v_exp_f32 v167, v167
  v_add_f32 v160, 1.0, v160
  v_add_f32 v161, 1.0, v161
  v_add_f32 v162, 1.0, v162
  v_add_f32 v163, 1.0, v163
  v_add_f32 v164, 1.0, v164
  v_add_f32 v165, 1.0, v165
  v_add_f32 v166, 1.0, v166
  v_add_f32 v167, 1.0, v167
  v_rcp_f32 v160, v160
  v_rcp_f32 v161, v161
  v_rcp_f32 v162, v162
  v_rcp_f32 v163, v163
  v_rcp_f32 v164, v164
  v_rcp_f32 v165, v165
  v_rcp_f32 v166, v166
  v_rcp_f32 v167, v167
  v_mul_f32 v160, v160, v96
  v_mul_f32 v161, v161, v97
  v_mul_f32 v162, v162, v98
  v_mul_f32 v163, v163, v99
  v_mul_f32 v164, v164, v100
  v_mul_f32 v165, v165, v101
  v_mul_f32 v166, v166, v102
  v_mul_f32 v167, v167, v103
  v_cvt_pk_bf16_f32 v144, v160, v161
  v_cvt_pk_bf16_f32 v145, v162, v163
  v_cvt_pk_bf16_f32 v146, v164, v165
  v_cvt_pk_bf16_f32 v147, v166, v167
  buffer_store_dwordx4 v[144:147], v54, s[16:19], s71 offen offset:2048 sc1
  v_mul_f32 v160, s74, v104
  v_mul_f32 v161, s74, v105
  v_mul_f32 v162, s74, v106
  v_mul_f32 v163, s74, v107
  v_mul_f32 v164, s74, v108
  v_mul_f32 v165, s74, v109
  v_mul_f32 v166, s74, v110
  v_mul_f32 v167, s74, v111
  v_exp_f32 v160, v160
  v_exp_f32 v161, v161
  v_exp_f32 v162, v162
  v_exp_f32 v163, v163
  v_exp_f32 v164, v164
  v_exp_f32 v165, v165
  v_exp_f32 v166, v166
  v_exp_f32 v167, v167
  v_add_f32 v160, 1.0, v160
  v_add_f32 v161, 1.0, v161
  v_add_f32 v162, 1.0, v162
  v_add_f32 v163, 1.0, v163
  v_add_f32 v164, 1.0, v164
  v_add_f32 v165, 1.0, v165
  v_add_f32 v166, 1.0, v166
  v_add_f32 v167, 1.0, v167
  v_rcp_f32 v160, v160
  v_rcp_f32 v161, v161
  v_rcp_f32 v162, v162
  v_rcp_f32 v163, v163
  v_rcp_f32 v164, v164
  v_rcp_f32 v165, v165
  v_rcp_f32 v166, v166
  v_rcp_f32 v167, v167
  v_mul_f32 v160, v160, v104
  v_mul_f32 v161, v161, v105
  v_mul_f32 v162, v162, v106
  v_mul_f32 v163, v163, v107
  v_mul_f32 v164, v164, v108
  v_mul_f32 v165, v165, v109
  v_mul_f32 v166, v166, v110
  v_mul_f32 v167, v167, v111
  v_cvt_pk_bf16_f32 v148, v160, v161
  v_cvt_pk_bf16_f32 v149, v162, v163
  v_cvt_pk_bf16_f32 v150, v164, v165
  v_cvt_pk_bf16_f32 v151, v166, v167
  buffer_store_dwordx4 v[148:151], v54, s[16:19], s71 offen offset:3072 sc1
  v_mul_f32 v160, s74, v112
  v_mul_f32 v161, s74, v113
  v_mul_f32 v162, s74, v114
  v_mul_f32 v163, s74, v115
  v_mul_f32 v164, s74, v116
  v_mul_f32 v165, s74, v117
  v_mul_f32 v166, s74, v118
  v_mul_f32 v167, s74, v119
  v_exp_f32 v160, v160
  v_exp_f32 v161, v161
  v_exp_f32 v162, v162
  v_exp_f32 v163, v163
  v_exp_f32 v164, v164
  v_exp_f32 v165, v165
  v_exp_f32 v166, v166
  v_exp_f32 v167, v167
  v_add_f32 v160, 1.0, v160
  v_add_f32 v161, 1.0, v161
  v_add_f32 v162, 1.0, v162
  v_add_f32 v163, 1.0, v163
  v_add_f32 v164, 1.0, v164
  v_add_f32 v165, 1.0, v165
  v_add_f32 v166, 1.0, v166
  v_add_f32 v167, 1.0, v167
  v_rcp_f32 v160, v160
  v_rcp_f32 v161, v161
  v_rcp_f32 v162, v162
  v_rcp_f32 v163, v163
  v_rcp_f32 v164, v164
  v_rcp_f32 v165, v165
  v_rcp_f32 v166, v166
  v_rcp_f32 v167, v167
  v_mul_f32 v160, v160, v112
  v_mul_f32 v161, v161, v113
  v_mul_f32 v162, v162, v114
  v_mul_f32 v163, v163, v115
  v_mul_f32 v164, v164, v116
  v_mul_f32 v165, v165, v117
  v_mul_f32 v166, v166, v118
  v_mul_f32 v167, v167, v119
  v_cvt_pk_bf16_f32 v152, v160, v161
  v_cvt_pk_bf16_f32 v153, v162, v163
  v_cvt_pk_bf16_f32 v154, v164, v165
  v_cvt_pk_bf16_f32 v155, v166, v167
  buffer_store_dwordx4 v[152:155], v54, s[16:19], s66 offen offset:2048 sc1
  v_mul_f32 v160, s74, v120
  v_mul_f32 v161, s74, v121
  v_mul_f32 v162, s74, v122
  v_mul_f32 v163, s74, v123
  v_mul_f32 v164, s74, v124
  v_mul_f32 v165, s74, v125
  v_mul_f32 v166, s74, v126
  v_mul_f32 v167, s74, v127
  v_exp_f32 v160, v160
  v_exp_f32 v161, v161
  v_exp_f32 v162, v162
  v_exp_f32 v163, v163
  v_exp_f32 v164, v164
  v_exp_f32 v165, v165
  v_exp_f32 v166, v166
  v_exp_f32 v167, v167
  v_add_f32 v160, 1.0, v160
  v_add_f32 v161, 1.0, v161
  v_add_f32 v162, 1.0, v162
  v_add_f32 v163, 1.0, v163
  v_add_f32 v164, 1.0, v164
  v_add_f32 v165, 1.0, v165
  v_add_f32 v166, 1.0, v166
  v_add_f32 v167, 1.0, v167
  v_rcp_f32 v160, v160
  v_rcp_f32 v161, v161
  v_rcp_f32 v162, v162
  v_rcp_f32 v163, v163
  v_rcp_f32 v164, v164
  v_rcp_f32 v165, v165
  v_rcp_f32 v166, v166
  v_rcp_f32 v167, v167
  v_mul_f32 v160, v160, v120
  v_mul_f32 v161, v161, v121
  v_mul_f32 v162, v162, v122
  v_mul_f32 v163, v163, v123
  v_mul_f32 v164, v164, v124
  v_mul_f32 v165, v165, v125
  v_mul_f32 v166, v166, v126
  v_mul_f32 v167, v167, v127
  v_cvt_pk_bf16_f32 v156, v160, v161
  v_cvt_pk_bf16_f32 v157, v162, v163
  v_cvt_pk_bf16_f32 v158, v164, v165
  v_cvt_pk_bf16_f32 v159, v166, v167
  buffer_store_dwordx4 v[156:159], v54, s[16:19], s66 offen offset:3072 sc1
  v_mov_b32 v62, 162880
RW_17:
  ds_read_b64 v[60:61], v62
  s_waitcnt lgkmcnt(0)
  v_cmp_ne_u32 vcc, 1, v61
  s_cbranch_vccz RW_18
  s_sleep 1
  s_branch RW_17
RW_18:
  s_waitcnt vmcnt(0)
  v_mov_b32 v52, 0
  s_mov_b64 exec, 1
  buffer_store_dword v60, v52, s[16:19], s32 offen sc1
  s_mov_b64 exec, -1
K_G2:
  ds_read_b32 v52, v51 offset:48
  s_waitcnt lgkmcnt(0)
  v_cmp_gt_u32 vcc, 12, v52
  s_cbranch_vccz LWD_20
LW_19:
  s_sleep 1
  ds_read_b32 v52, v51 offset:48
  s_waitcnt lgkmcnt(0)
  v_cmp_gt_u32 vcc, 12, v52
  s_cbranch_vccnz LW_19
LWD_20:
  s_setprio 0
  ds_read_b64_tr_b16 v[128:129], v56 offset:4096
  ds_read_b64_tr_b16 v[130:131], v56 offset:5120
  ds_read_b64_tr_b16 v[132:133], v57 offset:4096
  ds_read_b64_tr_b16 v[134:135], v57 offset:5120
  ds_read_b64_tr_b16 v[136:137], v56 offset:6144
  ds_read_b64_tr_b16 v[138:139], v56 offset:7168
  ds_read_b64_tr_b16 v[140:141], v57 offset:6144
  ds_read_b64_tr_b16 v[142:143], v57 offset:7168
  ds_read_b64_tr_b16 v[144:145], v56 offset:8192
  ds_read_b64_tr_b16 v[146:147], v56 offset:9216
  ds_read_b64_tr_b16 v[148:149], v57 offset:8192
  ds_read_b64_tr_b16 v[150:151], v57 offset:9216
  ds_read_b64_tr_b16 v[152:153], v56 offset:10240
  ds_read_b64_tr_b16 v[154:155], v56 offset:11264
  ds_read_b64_tr_b16 v[156:157], v57 offset:10240
  ds_read_b64_tr_b16 v[158:159], v57 offset:11264
  ds_read_b64_tr_b16 v[160:161], v56 offset:12288
  ds_read_b64_tr_b16 v[162:163], v56 offset:13312
  ds_read_b64_tr_b16 v[164:165], v57 offset:12288
  ds_read_b64_tr_b16 v[166:167], v57 offset:13312
  ds_read_b64_tr_b16 v[168:169], v56 offset:14336
  ds_read_b64_tr_b16 v[170:171], v56 offset:15360
  ds_read_b64_tr_b16 v[172:173], v57 offset:14336
  ds_read_b64_tr_b16 v[174:175], v57 offset:15360
  ds_read_b64_tr_b16 v[176:177], v56 offset:16384
  ds_read_b64_tr_b16 v[178:179], v56 offset:17408
  ds_read_b64_tr_b16 v[180:181], v57 offset:16384
  ds_read_b64_tr_b16 v[182:183], v57 offset:17408
  ds_read_b64_tr_b16 v[224:225], v56 offset:18432
  ds_read_b64_tr_b16 v[226:227], v56 offset:19456
  ds_read_b64_tr_b16 v[228:229], v57 offset:18432
  ds_read_b64_tr_b16 v[230:231], v57 offset:19456
  ds_read_b64_tr_b16 v[232:233], v56 offset:20480
  ds_read_b64_tr_b16 v[234:235], v56 offset:21504
  ds_read_b64_tr_b16 v[236:237], v57 offset:20480
  ds_read_b64_tr_b16 v[238:239], v57 offset:21504
  ds_read_b64_tr_b16 v[240:241], v56 offset:22528
  ds_read_b64_tr_b16 v[242:243], v56 offset:23552
  ds_read_b64_tr_b16 v[244:245], v57 offset:22528
  ds_read_b64_tr_b16 v[246:247], v57 offset:23552
  ds_read_b64_tr_b16 v[248:249], v56 offset:24576
  ds_read_b64_tr_b16 v[250:251], v56 offset:25600
  ds_read_b64_tr_b16 v[252:253], v57 offset:24576
  ds_read_b64_tr_b16 v[254:255], v57 offset:25600
  ds_read_b64_tr_b16 v[2:3], v56 offset:26624
  ds_read_b64_tr_b16 v[4:5], v56 offset:27648
  ds_read_b64_tr_b16 v[6:7], v57 offset:26624
  ds_read_b64_tr_b16 v[8:9], v57 offset:27648
  ds_read_b64_tr_b16 v[10:11], v56 offset:28672
  ds_read_b64_tr_b16 v[12:13], v56 offset:29696
  ds_read_b64_tr_b16 v[14:15], v57 offset:28672
  ds_read_b64_tr_b16 v[16:17], v57 offset:29696
  ds_read_b64_tr_b16 v[18:19], v56 offset:30720
  ds_read_b64_tr_b16 v[20:21], v56 offset:31744
  ds_read_b64_tr_b16 v[22:23], v57 offset:30720
  ds_read_b64_tr_b16 v[24:25], v57 offset:31744
  v_lshrrev_b32 v28, 3, v1
  v_and_b32 v29, 7, v1
  v_bfe_u32 v27, v1, 4, 1
  v_lshlrev_b32 v28, 10, v28
  v_lshlrev_b32 v27, 2, v27
  v_xor_b32 v27, v29, v27
  v_lshl_add_u32 v26, v27, 4, v28
  v_add_u32 v27, 7168, v26
  s_waitcnt lgkmcnt(12)
  s_add_u32 m0, s83, 4096
  s_add_u32 s69, s82, 229376
  buffer_load_dwordx4 v26, s[12:15], s69 offen  lds
  buffer_load_dwordx4 v27, s[12:15], s69 offen offset:1024  lds
  s_add_u32 m0, s83, 6144
  s_add_u32 s69, s82, 245760
  buffer_load_dwordx4 v26, s[12:15], s69 offen  lds
  buffer_load_dwordx4 v27, s[12:15], s69 offen offset:1024  lds
  s_add_u32 m0, s83, 8192
  s_add_u32 s69, s82, 262144
  buffer_load_dwordx4 v26, s[12:15], s69 offen  lds
  buffer_load_dwordx4 v27, s[12:15], s69 offen offset:1024  lds
  s_add_u32 m0, s83, 10240
  s_add_u32 s69, s82, 278528
  buffer_load_dwordx4 v26, s[12:15], s69 offen  lds
  buffer_load_dwordx4 v27, s[12:15], s69 offen offset:1024  lds
  s_add_u32 m0, s83, 12288
  s_add_u32 s69, s82, 294912
  buffer_load_dwordx4 v26, s[12:15], s69 offen  lds
  buffer_load_dwordx4 v27, s[12:15], s69 offen offset:1024  lds
  s_add_u32 m0, s83, 14336
  s_add_u32 s69, s82, 311296
  buffer_load_dwordx4 v26, s[12:15], s69 offen  lds
  buffer_load_dwordx4 v27, s[12:15], s69 offen offset:1024  lds
  s_add_u32 m0, s83, 16384
  s_add_u32 s69, s82, 327680
  buffer_load_dwordx4 v26, s[12:15], s69 offen  lds
  buffer_load_dwordx4 v27, s[12:15], s69 offen offset:1024  lds
  s_add_u32 m0, s83, 18432
  s_add_u32 s69, s82, 344064
  buffer_load_dwordx4 v26, s[12:15], s69 offen  lds
  buffer_load_dwordx4 v27, s[12:15], s69 offen offset:1024  lds
  s_add_u32 m0, s83, 20480
  s_add_u32 s69, s82, 360448
  buffer_load_dwordx4 v26, s[12:15], s69 offen  lds
  buffer_load_dwordx4 v27, s[12:15], s69 offen offset:1024  lds
  s_add_u32 m0, s83, 22528
  s_add_u32 s69, s82, 376832
  buffer_load_dwordx4 v26, s[12:15], s69 offen  lds
  buffer_load_dwordx4 v27, s[12:15], s69 offen offset:1024  lds
  s_add_u32 m0, s83, 24576
  s_add_u32 s69, s82, 393216
  buffer_load_dwordx4 v26, s[12:15], s69 offen  lds
  buffer_load_dwordx4 v27, s[12:15], s69 offen offset:1024  lds
  s_waitcnt lgkmcnt(0)
  s_add_u32 m0, s83, 26624
  s_add_u32 s69, s82, 409600
  buffer_load_dwordx4 v26, s[12:15], s69 offen  lds
  buffer_load_dwordx4 v27, s[12:15], s69 offen offset:1024  lds
  s_add_u32 m0, s83, 28672
  s_add_u32 s69, s82, 425984
  buffer_load_dwordx4 v26, s[12:15], s69 offen  lds
  buffer_load_dwordx4 v27, s[12:15], s69 offen offset:1024  lds
  s_add_u32 m0, s83, 30720
  s_add_u32 s69, s82, 442368
  buffer_load_dwordx4 v26, s[12:15], s69 offen  lds
  buffer_load_dwordx4 v27, s[12:15], s69 offen offset:1024  lds
K_G3:
  s_mov_b32 s85, 100000
PH_21:
  buffer_load_dword v52, v59, s[16:19], 0 offen sc1
  s_waitcnt vmcnt(0)
  v_cmp_ne_u32 vcc, v60, v52
  s_cbranch_vccz PH_22
  s_sleep 2
  s_sub_u32 s85, s85, 1
  s_cbranch_scc0 PH_21
PH_22:
  s_waitcnt lgkmcnt(0)
K_HD:
  s_add_u32 s69, s80, 0
  buffer_load_dwordx4 v[184:187], v54, s[16:19], s69 offen offset:0 sc1
  buffer_load_dwordx4 v[188:191], v54, s[16:19], s69 offen offset:1024 sc1
  buffer_load_dwordx4 v[192:195], v54, s[16:19], s69 offen offset:2048 sc1
  buffer_load_dwordx4 v[196:199], v54, s[16:19], s69 offen offset:3072 sc1
  s_add_u32 s69, s80, 4096
  buffer_load_dwordx4 v[200:203], v54, s[16:19], s69 offen offset:0 sc1
  buffer_load_dwordx4 v[204:207], v54, s[16:19], s69 offen offset:1024 sc1
  buffer_load_dwordx4 v[208:211], v54, s[16:19], s69 offen offset:2048 sc1
  buffer_load_dwordx4 v[212:215], v54, s[16:19], s69 offen offset:3072 sc1
  s_add_u32 s69, s80, 8192
  buffer_load_dwordx4 v[216:219], v54, s[16:19], s69 offen offset:0 sc1
  buffer_load_dwordx4 v[220:223], v54, s[16:19], s69 offen offset:1024 sc1
  s_waitcnt vmcnt(9)
  v_mfma_f32_32x32x16_bf16 v[80:95], v[132:135], v[184:187], 0
  v_mfma_f32_32x32x16_bf16 v[64:79], v[128:131], v[184:187], 0
  s_waitcnt vmcnt(8)
  v_mfma_f32_32x32x16_bf16 v[80:95], v[140:143], v[188:191], v[80:95]
  buffer_load_dwordx4 v[184:187], v54, s[16:19], s69 offen offset:2048 sc1
  v_mfma_f32_32x32x16_bf16 v[64:79], v[136:139], v[188:191], v[64:79]
  s_waitcnt vmcnt(8)
  v_mfma_f32_32x32x16_bf16 v[80:95], v[148:151], v[192:195], v[80:95]
  buffer_load_dwordx4 v[188:191], v54, s[16:19], s69 offen offset:3072 sc1
  v_mfma_f32_32x32x16_bf16 v[64:79], v[144:147], v[192:195], v[64:79]
  s_waitcnt vmcnt(8)
  v_mfma_f32_32x32x16_bf16 v[80:95], v[156:159], v[196:199], v[80:95]
  s_add_u32 s69, s80, 12288
  buffer_load_dwordx4 v[192:195], v54, s[16:19], s69 offen offset:0 sc1
  v_mfma_f32_32x32x16_bf16 v[64:79], v[152:155], v[196:199], v[64:79]
  s_waitcnt vmcnt(8)
  v_mfma_f32_32x32x16_bf16 v[80:95], v[164:167], v[200:203], v[80:95]
  buffer_load_dwordx4 v[196:199], v54, s[16:19], s69 offen offset:1024 sc1
  v_mfma_f32_32x32x16_bf16 v[64:79], v[160:163], v[200:203], v[64:79]
  s_waitcnt vmcnt(8)
  v_mfma_f32_32x32x16_bf16 v[80:95], v[172:175], v[204:207], v[80:95]
  s_add_u32 s69, s81, 0
  buffer_load_dwordx4 v[200:203], v54, s[16:19], s69 offen offset:0 sc1
  v_mfma_f32_32x32x16_bf16 v[64:79], v[168:171], v[204:207], v[64:79]
  s_waitcnt vmcnt(8)
  v_mfma_f32_32x32x16_bf16 v[80:95], v[180:183], v[208:211], v[80:95]
  buffer_load_dwordx4 v[204:207], v54, s[16:19], s69 offen offset:1024 sc1
  v_mfma_f32_32x32x16_bf16 v[64:79], v[176:179], v[208:211], v[64:79]
  s_waitcnt vmcnt(8)
  v_mfma_f32_32x32x16_bf16 v[80:95], v[228:231], v[212:215], v[80:95]
  buffer_load_dwordx4 v[208:211], v54, s[16:19], s69 offen offset:2048 sc1
  v_mfma_f32_32x32x16_bf16 v[64:79], v[224:227], v[212:215], v[64:79]
  s_waitcnt vmcnt(8)
  v_mfma_f32_32x32x16_bf16 v[80:95], v[236:239], v[216:219], v[80:95]
  buffer_load_dwordx4 v[212:215], v54, s[16:19], s69 offen offset:3072 sc1
  v_mfma_f32_32x32x16_bf16 v[64:79], v[232:235], v[216:219], v[64:79]
  s_waitcnt vmcnt(8)
  v_mfma_f32_32x32x16_bf16 v[80:95], v[244:247], v[220:223], v[80:95]
  s_add_u32 s69, s81, 4096
  buffer_load_dwordx4 v[216:219], v54, s[16:19], s69 offen offset:0 sc1
  v_mfma_f32_32x32x16_bf16 v[64:79], v[240:243], v[220:223], v[64:79]
  s_waitcnt vmcnt(8)
  v_mfma_f32_32x32x16_bf16 v[80:95], v[252:255], v[184:187], v[80:95]
  buffer_load_dwordx4 v[220:223], v54, s[16:19], s69 offen offset:1024 sc1
  v_mfma_f32_32x32x16_bf16 v[64:79], v[248:251], v[184:187], v[64:79]
  s_waitcnt vmcnt(8)
  v_mfma_f32_32x32x16_bf16 v[80:95], v[6:9], v[188:191], v[80:95]
  buffer_load_dwordx4 v[184:187], v54, s[16:19], s69 offen offset:2048 sc1
  v_mfma_f32_32x32x16_bf16 v[64:79], v[2:5], v[188:191], v[64:79]
  s_waitcnt vmcnt(8)
  v_mfma_f32_32x32x16_bf16 v[80:95], v[14:17], v[192:195], v[80:95]
  buffer_load_dwordx4 v[188:191], v54, s[16:19], s69 offen offset:3072 sc1
  v_mfma_f32_32x32x16_bf16 v[64:79], v[10:13], v[192:195], v[64:79]
  s_waitcnt vmcnt(8)
  v_mfma_f32_32x32x16_bf16 v[80:95], v[22:25], v[196:199], v[80:95]
  s_add_u32 s69, s81, 8192
  buffer_load_dwordx4 v[192:195], v54, s[16:19], s69 offen offset:0 sc1
  v_mfma_f32_32x32x16_bf16 v[64:79], v[18:21], v[196:199], v[64:79]
  s_waitcnt vmcnt(8)
  v_mfma_f32_32x32x16_bf16 v[112:127], v[132:135], v[200:203], 0
  buffer_load_dwordx4 v[196:199], v54, s[16:19], s69 offen offset:1024 sc1
  v_mfma_f32_32x32x16_bf16 v[96:111], v[128:131], v[200:203], 0
  s_waitcnt vmcnt(8)
  v_mfma_f32_32x32x16_bf16 v[112:127], v[140:143], v[204:207], v[112:127]
  buffer_load_dwordx4 v[200:203], v54, s[16:19], s69 offen offset:2048 sc1
  v_mfma_f32_32x32x16_bf16 v[96:111], v[136:139], v[204:207], v[96:111]
  s_waitcnt vmcnt(8)
  v_mfma_f32_32x32x16_bf16 v[112:127], v[148:151], v[208:211], v[112:127]
  buffer_load_dwordx4 v[204:207], v54, s[16:19], s69 offen offset:3072 sc1
  v_mfma_f32_32x32x16_bf16 v[96:111], v[144:147], v[208:211], v[96:111]
  s_waitcnt vmcnt(8)
  v_mfma_f32_32x32x16_bf16 v[112:127], v[156:159], v[212:215], v[112:127]
  s_add_u32 s69, s81, 12288
  buffer_load_dwordx4 v[208:211], v54, s[16:19], s69 offen offset:0 sc1
  v_mfma_f32_32x32x16_bf16 v[96:111], v[152:155], v[212:215], v[96:111]
  s_waitcnt vmcnt(8)
  v_mfma_f32_32x32x16_bf16 v[112:127], v[164:167], v[216:219], v[112:127]
  buffer_load_dwordx4 v[212:215], v54, s[16:19], s69 offen offset:1024 sc1
  v_mfma_f32_32x32x16_bf16 v[96:111], v[160:163], v[216:219], v[96:111]
  s_waitcnt vmcnt(8)
  v_mfma_f32_32x32x16_bf16 v[112:127], v[172:175], v[220:223], v[112:127]
  s_add_u32 s69, s80, 14336
  buffer_load_dwordx4 v[216:219], v54, s[16:19], s69 offen offset:0 sc1
  v_mfma_f32_32x32x16_bf16 v[96:111], v[168:171], v[220:223], v[96:111]
  s_waitcnt vmcnt(8)
  v_mfma_f32_32x32x16_bf16 v[112:127], v[180:183], v[184:187], v[112:127]
  buffer_load_dwordx4 v[220:223], v54, s[16:19], s69 offen offset:1024 sc1
  v_mfma_f32_32x32x16_bf16 v[96:111], v[176:179], v[184:187], v[96:111]
  s_waitcnt vmcnt(8)
  v_mfma_f32_32x32x16_bf16 v[112:127], v[228:231], v[188:191], v[112:127]
  buffer_load_dwordx4 v[184:187], v54, s[16:19], s69 offen offset:2048 sc1
  v_mfma_f32_32x32x16_bf16 v[96:111], v[224:227], v[188:191], v[96:111]
  s_waitcnt vmcnt(8)
  v_mfma_f32_32x32x16_bf16 v[112:127], v[236:239], v[192:195], v[112:127]
  buffer_load_dwordx4 v[188:191], v54, s[16:19], s69 offen offset:3072 sc1
  v_mfma_f32_32x32x16_bf16 v[96:111], v[232:235], v[192:195], v[96:111]
  s_waitcnt vmcnt(8)
  v_mfma_f32_32x32x16_bf16 v[112:127], v[244:247], v[196:199], v[112:127]
  s_add_u32 s69, s80, 18432
  buffer_load_dwordx4 v[192:195], v54, s[16:19], s69 offen offset:0 sc1
  v_mfma_f32_32x32x16_bf16 v[96:111], v[240:243], v[196:199], v[96:111]
  s_waitcnt vmcnt(8)
  v_mfma_f32_32x32x16_bf16 v[112:127], v[252:255], v[200:203], v[112:127]
  buffer_load_dwordx4 v[196:199], v54, s[16:19], s69 offen offset:1024 sc1
  v_mfma_f32_32x32x16_bf16 v[96:111], v[248:251], v[200:203], v[96:111]
  s_waitcnt vmcnt(8)
  v_mfma_f32_32x32x16_bf16 v[112:127], v[6:9], v[204:207], v[112:127]
  ds_read_b64_tr_b16 v[128:129], v56 offset:4096
  ds_read_b64_tr_b16 v[130:131], v56 offset:5120
  buffer_load_dwordx4 v[200:203], v54, s[16:19], s69 offen offset:2048 sc1
  v_mfma_f32_32x32x16_bf16 v[96:111], v[2:5], v[204:207], v[96:111]
  ds_read_b64_tr_b16 v[132:133], v57 offset:4096
  ds_read_b64_tr_b16 v[134:135], v57 offset:5120
  s_waitcnt vmcnt(8)
  v_mfma_f32_32x32x16_bf16 v[112:127], v[14:17], v[208:211], v[112:127]
  ds_read_b64_tr_b16 v[136:137], v56 offset:6144
  ds_read_b64_tr_b16 v[138:139], v56 offset:7168
  buffer_load_dwordx4 v[204:207], v54, s[16:19], s69 offen offset:3072 sc1
  v_mfma_f32_32x32x16_bf16 v[96:111], v[10:13], v[208:211], v[96:111]
  ds_read_b64_tr_b16 v[140:141], v57 offset:6144
  ds_read_b64_tr_b16 v[142:143], v57 offset:7168
  s_waitcnt vmcnt(8)
  v_mfma_f32_32x32x16_bf16 v[112:127], v[22:25], v[212:215], v[112:127]
  ds_read_b64_tr_b16 v[144:145], v56 offset:8192
  ds_read_b64_tr_b16 v[146:147], v56 offset:9216
  s_add_u32 s69, s80, 22528
  buffer_load_dwordx4 v[208:211], v54, s[16:19], s69 offen offset:0 sc1
  v_mfma_f32_32x32x16_bf16 v[96:111], v[18:21], v[212:215], v[96:111]
  ds_read_b64_tr_b16 v[148:149], v57 offset:8192
  ds_read_b64_tr_b16 v[150:151], v57 offset:9216
  s_waitcnt vmcnt(8) lgkmcnt(8)
  v_mfma_f32_32x32x16_bf16 v[80:95], v[132:135], v[216:219], v[80:95]
  ds_read_b64_tr_b16 v[152:153], v56 offset:10240
  ds_read_b64_tr_b16 v[154:155], v56 offset:11264
  buffer_load_dwordx4 v[212:215], v54, s[16:19], s69 offen offset:1024 sc1
  v_mfma_f32_32x32x16_bf16 v[64:79], v[128:131], v[216:219], v[64:79]
  ds_read_b64_tr_b16 v[156:157], v57 offset:10240
  ds_read_b64_tr_b16 v[158:159], v57 offset:11264
  s_waitcnt vmcnt(8) lgkmcnt(8)
  v_mfma_f32_32x32x16_bf16 v[80:95], v[140:143], v[220:223], v[80:95]
  ds_read_b64_tr_b16 v[160:161], v56 offset:12288
  ds_read_b64_tr_b16 v[162:163], v56 offset:13312
  buffer_load_dwordx4 v[216:219], v54, s[16:19], s69 offen offset:2048 sc1
  v_mfma_f32_32x32x16_bf16 v[64:79], v[136:139], v[220:223], v[64:79]
  ds_read_b64_tr_b16 v[164:165], v57 offset:12288
  ds_read_b64_tr_b16 v[166:167], v57 offset:13312
  s_waitcnt vmcnt(8) lgkmcnt(8)
  v_mfma_f32_32x32x16_bf16 v[80:95], v[148:151], v[184:187], v[80:95]
  ds_read_b64_tr_b16 v[168:169], v56 offset:14336
  ds_read_b64_tr_b16 v[170:171], v56 offset:15360
  buffer_load_dwordx4 v[220:223], v54, s[16:19], s69 offen offset:3072 sc1
  v_mov_b32 v53, 9
  v_mfma_f32_32x32x16_bf16 v[64:79], v[144:147], v[184:187], v[64:79]
  ds_read_b64_tr_b16 v[172:173], v57 offset:14336
  ds_read_b64_tr_b16 v[174:175], v57 offset:15360
  ds_write_b32 v50, v53 offset:16
  s_waitcnt vmcnt(8) lgkmcnt(9)
  v_mfma_f32_32x32x16_bf16 v[80:95], v[156:159], v[188:191], v[80:95]
  ds_read_b64_tr_b16 v[176:177], v56 offset:16384
  ds_read_b64_tr_b16 v[178:179], v56 offset:17408
  s_add_u32 s69, s80, 26624
  buffer_load_dwordx4 v[184:187], v54, s[16:19], s69 offen offset:0 sc1
  v_mfma_f32_32x32x16_bf16 v[64:79], v[152:155], v[188:191], v[64:79]
  ds_read_b64_tr_b16 v[180:181], v57 offset:16384
  ds_read_b64_tr_b16 v[182:183], v57 offset:17408
  s_waitcnt vmcnt(8) lgkmcnt(9)
  v_mfma_f32_32x32x16_bf16 v[80:95], v[164:167], v[192:195], v[80:95]
  ds_read_b64_tr_b16 v[224:225], v56 offset:18432
  ds_read_b64_tr_b16 v[226:227], v56 offset:19456
  buffer_load_dwordx4 v[188:191], v54, s[16:19], s69 offen offset:1024 sc1
  v_mfma_f32_32x32x16_bf16 v[64:79], v[160:163], v[192:195], v[64:79]
  ds_read_b64_tr_b16 v[228:229], v57 offset:18432
  ds_read_b64_tr_b16 v[230:231], v57 offset:19456
  s_waitcnt vmcnt(8) lgkmcnt(8)
  v_mfma_f32_32x32x16_bf16 v[80:95], v[172:175], v[196:199], v[80:95]
  ds_read_b64_tr_b16 v[232:233], v56 offset:20480
  ds_read_b64_tr_b16 v[234:235], v56 offset:21504
  s_add_u32 s69, s81, 14336
  buffer_load_dwordx4 v[192:195], v54, s[16:19], s69 offen offset:0 sc1
  v_mfma_f32_32x32x16_bf16 v[64:79], v[168:171], v[196:199], v[64:79]
  ds_read_b64_tr_b16 v[236:237], v57 offset:20480
  ds_read_b64_tr_b16 v[238:239], v57 offset:21504
  s_waitcnt vmcnt(8) lgkmcnt(8)
  v_mfma_f32_32x32x16_bf16 v[80:95], v[180:183], v[200:203], v[80:95]
  ds_read_b64_tr_b16 v[240:241], v56 offset:22528
  ds_read_b64_tr_b16 v[242:243], v56 offset:23552
  buffer_load_dwordx4 v[196:199], v54, s[16:19], s69 offen offset:1024 sc1
  v_mfma_f32_32x32x16_bf16 v[64:79], v[176:179], v[200:203], v[64:79]
  ds_read_b64_tr_b16 v[244:245], v57 offset:22528
  ds_read_b64_tr_b16 v[246:247], v57 offset:23552
  s_waitcnt vmcnt(8) lgkmcnt(8)
  v_mfma_f32_32x32x16_bf16 v[80:95], v[228:231], v[204:207], v[80:95]
  ds_read_b64_tr_b16 v[248:249], v56 offset:24576
  ds_read_b64_tr_b16 v[250:251], v56 offset:25600
  buffer_load_dwordx4 v[200:203], v54, s[16:19], s69 offen offset:2048 sc1
  v_mfma_f32_32x32x16_bf16 v[64:79], v[224:227], v[204:207], v[64:79]
  ds_read_b64_tr_b16 v[252:253], v57 offset:24576
  ds_read_b64_tr_b16 v[254:255], v57 offset:25600
  s_waitcnt vmcnt(8) lgkmcnt(8)
  v_mfma_f32_32x32x16_bf16 v[80:95], v[236:239], v[208:211], v[80:95]
  ds_read_b64_tr_b16 v[2:3], v56 offset:26624
  ds_read_b64_tr_b16 v[4:5], v56 offset:27648
  buffer_load_dwordx4 v[204:207], v54, s[16:19], s69 offen offset:3072 sc1
  v_mfma_f32_32x32x16_bf16 v[64:79], v[232:235], v[208:211], v[64:79]
  ds_read_b64_tr_b16 v[6:7], v57 offset:26624
  ds_read_b64_tr_b16 v[8:9], v57 offset:27648
  s_waitcnt vmcnt(8) lgkmcnt(8)
  v_mfma_f32_32x32x16_bf16 v[80:95], v[244:247], v[212:215], v[80:95]
  ds_read_b64_tr_b16 v[10:11], v56 offset:28672
  ds_read_b64_tr_b16 v[12:13], v56 offset:29696
  s_add_u32 s69, s81, 18432
  buffer_load_dwordx4 v[208:211], v54, s[16:19], s69 offen offset:0 sc1
  v_mfma_f32_32x32x16_bf16 v[64:79], v[240:243], v[212:215], v[64:79]
  ds_read_b64_tr_b16 v[14:15], v57 offset:28672
  ds_read_b64_tr_b16 v[16:17], v57 offset:29696
  s_waitcnt vmcnt(8) lgkmcnt(8)
  v_mfma_f32_32x32x16_bf16 v[80:95], v[252:255], v[216:219], v[80:95]
  ds_read_b64_tr_b16 v[18:19], v56 offset:30720
  ds_read_b64_tr_b16 v[20:21], v56 offset:31744
  buffer_load_dwordx4 v[212:215], v54, s[16:19], s69 offen offset:1024 sc1
  v_mfma_f32_32x32x16_bf16 v[64:79], v[248:251], v[216:219], v[64:79]
  ds_read_b64_tr_b16 v[22:23], v57 offset:30720
  ds_read_b64_tr_b16 v[24:25], v57 offset:31744
  s_waitcnt vmcnt(8) lgkmcnt(8)
  v_mfma_f32_32x32x16_bf16 v[80:95], v[6:9], v[220:223], v[80:95]
  buffer_load_dwordx4 v[216:219], v54, s[16:19], s69 offen offset:2048 sc1
  v_mfma_f32_32x32x16_bf16 v[64:79], v[2:5], v[220:223], v[64:79]
  s_waitcnt vmcnt(8) lgkmcnt(4)
  v_mfma_f32_32x32x16_bf16 v[80:95], v[14:17], v[184:187], v[80:95]
  buffer_load_dwordx4 v[220:223], v54, s[16:19], s69 offen offset:3072 sc1
  v_mfma_f32_32x32x16_bf16 v[64:79], v[10:13], v[184:187], v[64:79]
  s_waitcnt vmcnt(8) lgkmcnt(0)
  v_mfma_f32_32x32x16_bf16 v[80:95], v[22:25], v[188:191], v[80:95]
  s_add_u32 s69, s81, 22528
  buffer_load_dwordx4 v[184:187], v54, s[16:19], s69 offen offset:0 sc1
  v_mfma_f32_32x32x16_bf16 v[64:79], v[18:21], v[188:191], v[64:79]
  s_waitcnt vmcnt(8)
  v_mfma_f32_32x32x16_bf16 v[112:127], v[132:135], v[192:195], v[112:127]
  buffer_load_dwordx4 v[188:191], v54, s[16:19], s69 offen offset:1024 sc1
  v_mfma_f32_32x32x16_bf16 v[96:111], v[128:131], v[192:195], v[96:111]
  s_waitcnt vmcnt(8)
  v_mfma_f32_32x32x16_bf16 v[112:127], v[140:143], v[196:199], v[112:127]
  s_nop 1
  buffer_load_dwordx4 v[192:195], v54, s[16:19], s69 offen offset:2048 sc1
  ds_write_b128 v58, v[80:83] offset:4096
  ds_write_b128 v58, v[84:87] offset:5120
  v_mfma_f32_32x32x16_bf16 v[96:111], v[136:139], v[196:199], v[96:111]
  ds_write_b128 v58, v[88:91] offset:6144
  ds_write_b128 v58, v[92:95] offset:7168
  s_waitcnt vmcnt(8)
  v_mfma_f32_32x32x16_bf16 v[112:127], v[148:151], v[200:203], v[112:127]
  buffer_load_dwordx4 v[196:199], v54, s[16:19], s69 offen offset:3072 sc1
  ds_write_b128 v58, v[64:67] offset:0
  ds_write_b128 v58, v[68:71] offset:1024
  v_mfma_f32_32x32x16_bf16 v[96:111], v[144:147], v[200:203], v[96:111]
  ds_write_b128 v58, v[72:75] offset:2048
  ds_write_b128 v58, v[76:79] offset:3072
  s_waitcnt vmcnt(8)
  v_mfma_f32_32x32x16_bf16 v[112:127], v[156:159], v[204:207], v[112:127]
  s_add_u32 s69, s81, 26624
  buffer_load_dwordx4 v[200:203], v54, s[16:19], s69 offen offset:0 sc1
  v_mov_b32 v53, 10
  ds_write_b32 v50, v53 offset:16
  v_mfma_f32_32x32x16_bf16 v[96:111], v[152:155], v[204:207], v[96:111]
  s_waitcnt vmcnt(8)
  v_mfma_f32_32x32x16_bf16 v[112:127], v[164:167], v[208:211], v[112:127]
  buffer_load_dwordx4 v[204:207], v54, s[16:19], s69 offen offset:1024 sc1
  v_mfma_f32_32x32x16_bf16 v[96:111], v[160:163], v[208:211], v[96:111]
  s_waitcnt vmcnt(8)
  v_mfma_f32_32x32x16_bf16 v[112:127], v[172:175], v[212:215], v[112:127]
  v_mfma_f32_32x32x16_bf16 v[96:111], v[168:171], v[212:215], v[96:111]
  s_waitcnt vmcnt(7)
  v_mfma_f32_32x32x16_bf16 v[112:127], v[180:183], v[216:219], v[112:127]
  v_mfma_f32_32x32x16_bf16 v[96:111], v[176:179], v[216:219], v[96:111]
  s_waitcnt vmcnt(6)
  v_mfma_f32_32x32x16_bf16 v[112:127], v[228:231], v[220:223], v[112:127]
  v_mfma_f32_32x32x16_bf16 v[96:111], v[224:227], v[220:223], v[96:111]
  s_waitcnt vmcnt(5)
  v_mfma_f32_32x32x16_bf16 v[112:127], v[236:239], v[184:187], v[112:127]
  v_mfma_f32_32x32x16_bf16 v[96:111], v[232:235], v[184:187], v[96:111]
  s_waitcnt vmcnt(4)
  v_mfma_f32_32x32x16_bf16 v[112:127], v[244:247], v[188:191], v[112:127]
  v_mfma_f32_32x32x16_bf16 v[96:111], v[240:243], v[188:191], v[96:111]
  s_waitcnt vmcnt(3)
  v_mfma_f32_32x32x16_bf16 v[112:127], v[252:255], v[192:195], v[112:127]
  v_mfma_f32_32x32x16_bf16 v[96:111], v[248:251], v[192:195], v[96:111]
  s_waitcnt vmcnt(2)
  v_mfma_f32_32x32x16_bf16 v[112:127], v[6:9], v[196:199], v[112:127]
  v_mfma_f32_32x32x16_bf16 v[96:111], v[2:5], v[196:199], v[96:111]
  s_waitcnt vmcnt(1)
  v_mfma_f32_32x32x16_bf16 v[112:127], v[14:17], v[200:203], v[112:127]
  v_mfma_f32_32x32x16_bf16 v[96:111], v[10:13], v[200:203], v[96:111]
  s_waitcnt vmcnt(0)
  v_mfma_f32_32x32x16_bf16 v[112:127], v[22:25], v[204:207], v[112:127]
  v_mfma_f32_32x32x16_bf16 v[96:111], v[18:21], v[204:207], v[96:111]
  v_mov_b32 v52, 11
  v_xor_b32 v62, 8, v50
  s_lshl_b32 s69, s26, 8
  s_add_u32 s69, s69, 147456
  v_lshl_add_u32 v35, v1, 2, s69
  s_nop 6
  s_nop 1
  ds_write_b128 v58, v[112:115] offset:8192
  ds_write_b128 v58, v[116:119] offset:9216
  ds_write_b128 v58, v[120:123] offset:10240
  ds_write_b128 v58, v[124:127] offset:11264
  ds_write_b32 v50, v52 offset:16
  ds_read_b32 v53, v62 offset:16
  s_waitcnt lgkmcnt(0)
  v_cmp_gt_u32 vcc, 11, v53
  s_cbranch_vccz LWD_24
LW_23:
  ds_read_b32 v53, v62 offset:16
  s_waitcnt lgkmcnt(0)
  v_cmp_gt_u32 vcc, 11, v53
  s_cbranch_vccnz LW_23
LWD_24:
  ds_read_b128 v[18:21], v63 offset:8192
  ds_read_b128 v[22:25], v63 offset:9216
  ds_read_b128 v[26:29], v63 offset:10240
  ds_read_b128 v[30:33], v63 offset:11264
  ds_read_b32 v53, v50 offset:32
  s_waitcnt lgkmcnt(4)
  v_pk_add_f32 v[96:97], v[96:97], v[18:19]
  v_pk_add_f32 v[98:99], v[98:99], v[20:21]
  s_waitcnt lgkmcnt(3)
  v_pk_add_f32 v[100:101], v[100:101], v[22:23]
  v_pk_add_f32 v[102:103], v[102:103], v[24:25]
  s_waitcnt lgkmcnt(2)
  v_pk_add_f32 v[104:105], v[104:105], v[26:27]
  v_pk_add_f32 v[106:107], v[106:107], v[28:29]
  s_waitcnt lgkmcnt(1)
  v_pk_add_f32 v[108:109], v[108:109], v[30:31]
  v_pk_add_f32 v[110:111], v[110:111], v[32:33]
  s_waitcnt lgkmcnt(0)
  v_cmp_gt_u32 vcc, 100, v53
  s_cbranch_vccz LWD_26
LW_25:
  ds_read_b32 v53, v50 offset:32
  s_waitcnt lgkmcnt(0)
  v_cmp_gt_u32 vcc, 100, v53
  s_cbranch_vccnz LW_25
LWD_26:
  ds_read_b32 v34, v35
  ds_read_b128 v[2:5], v49 offset:0
  ds_read_b128 v[6:9], v49 offset:1024
  ds_read_b128 v[10:13], v49 offset:2048
  ds_read_b128 v[14:17], v49 offset:3072
  s_waitcnt lgkmcnt(3)
  v_pk_fma_f32 v[2:3], v[96:97], v[34:35], v[2:3] op_sel:[0,0,0] op_sel_hi:[1,0,1]
  v_pk_fma_f32 v[4:5], v[98:99], v[34:35], v[4:5] op_sel:[0,0,0] op_sel_hi:[1,0,1]
  s_waitcnt lgkmcnt(2)
  v_pk_fma_f32 v[6:7], v[100:101], v[34:35], v[6:7] op_sel:[0,0,0] op_sel_hi:[1,0,1]
  v_pk_fma_f32 v[8:9], v[102:103], v[34:35], v[8:9] op_sel:[0,0,0] op_sel_hi:[1,0,1]
  s_waitcnt lgkmcnt(1)
  v_pk_fma_f32 v[10:11], v[104:105], v[34:35], v[10:11] op_sel:[0,0,0] op_sel_hi:[1,0,1]
  v_pk_fma_f32 v[12:13], v[106:107], v[34:35], v[12:13] op_sel:[0,0,0] op_sel_hi:[1,0,1]
  s_waitcnt lgkmcnt(0)
  v_pk_fma_f32 v[14:15], v[108:109], v[34:35], v[14:15] op_sel:[0,0,0] op_sel_hi:[1,0,1]
  v_pk_fma_f32 v[16:17], v[110:111], v[34:35], v[16:17] op_sel:[0,0,0] op_sel_hi:[1,0,1]
  v_cvt_pk_bf16_f32 v168, v2, v3
  v_cvt_pk_bf16_f32 v169, v4, v5
  v_cvt_pk_bf16_f32 v170, v6, v7
  v_cvt_pk_bf16_f32 v171, v8, v9
  v_cvt_pk_bf16_f32 v172, v10, v11
  v_cvt_pk_bf16_f32 v173, v12, v13
  v_cvt_pk_bf16_f32 v174, v14, v15
  v_cvt_pk_bf16_f32 v175, v16, v17
  s_nop 1
  v_permlane32_swap_b32 v168, v170
  v_permlane32_swap_b32 v169, v171
  v_permlane32_swap_b32 v172, v174
  v_permlane32_swap_b32 v173, v175
  s_nop 1
  buffer_store_dwordx4 v[168:171], v55, s[20:23], s76 offen offset:0
  buffer_store_dwordx4 v[172:175], v55, s[20:23], s76 offen offset:32
  s_waitcnt lgkmcnt(0)
  s_endpgm
K_IDLE:
  s_setprio 3
  v_lshrrev_b32 v8, 3, v1
  v_and_b32 v9, 7, v1
  v_lshlrev_b32 v10, 10, v8
  v_lshl_add_u32 v10, v9, 4, v10
  s_sub_u32 s64, s25, 28
  s_lshl_b32 s64, s64, 2
  s_add_u32 s64, s64, s26
  s_and_b32 s33, s64, 1
  s_lshl_b32 s70, s24, 1
  s_add_u32 s33, s33, s70
  s_lshr_b32 s34, s64, 1
  s_lshl_b32 s65, s33, 17
  s_lshl_b32 s70, s34, 7
  s_add_u32 s65, s65, s70
  s_lshl_b32 s66, s26, 15
  s_getpc_b64 s[72:73]
K_PC:
  s_sub_u32 s72, s72, K_PC-gated_mix__ssm_conv_s4d__dense_activation_silu__prompt_kernel
  s_subb_u32 s73, s73, 0
  v_lshl_add_u32 v20, s64, 5, v1
  v_lshlrev_b32 v20, 7, v20
  v_min_u32 v20, K_END-gated_mix__ssm_conv_s4d__dense_activation_silu__prompt_kernel, v20
  s_mov_b64 exec, 0xffffffff
  global_load_dword v21, v20, s[72:73]
  s_mov_b64 exec, -1
  s_waitcnt lgkmcnt(0)
  s_mov_b32 s4, s36
  s_and_b32 s5, s37, 0xffff
  s_mov_b32 s6, 2097152
  s_mov_b32 s7, 0x20000
  s_add_u32 m0, s66, 0
  s_add_u32 s70, s65, 0
  buffer_load_dwordx4 v10, s[4:7], s70 offen  lds
  s_add_u32 m0, s66, 1024
  s_add_u32 s70, s65, 8192
  buffer_load_dwordx4 v10, s[4:7], s70 offen  lds
  s_add_u32 m0, s66, 2048
  s_add_u32 s70, s65, 16384
  buffer_load_dwordx4 v10, s[4:7], s70 offen  lds
  s_add_u32 m0, s66, 3072
  s_add_u32 s70, s65, 24576
  buffer_load_dwordx4 v10, s[4:7], s70 offen  lds
  s_add_u32 m0, s66, 4096
  s_add_u32 s70, s65, 32768
  buffer_load_dwordx4 v10, s[4:7], s70 offen  lds
  s_add_u32 m0, s66, 5120
  s_add_u32 s70, s65, 40960
  buffer_load_dwordx4 v10, s[4:7], s70 offen  lds
  s_add_u32 m0, s66, 6144
  s_add_u32 s70, s65, 49152
  buffer_load_dwordx4 v10, s[4:7], s70 offen  lds
  s_add_u32 m0, s66, 7168
  s_add_u32 s70, s65, 57344
  buffer_load_dwordx4 v10, s[4:7], s70 offen  lds
  s_add_u32 m0, s66, 8192
  s_add_u32 s70, s65, 65536
  buffer_load_dwordx4 v10, s[4:7], s70 offen  lds
  s_add_u32 m0, s66, 9216
  s_add_u32 s70, s65, 73728
  buffer_load_dwordx4 v10, s[4:7], s70 offen  lds
  s_add_u32 m0, s66, 10240
  s_add_u32 s70, s65, 81920
  buffer_load_dwordx4 v10, s[4:7], s70 offen  lds
  s_add_u32 m0, s66, 11264
  s_add_u32 s70, s65, 90112
  buffer_load_dwordx4 v10, s[4:7], s70 offen  lds
  s_add_u32 m0, s66, 12288
  s_add_u32 s70, s65, 98304
  buffer_load_dwordx4 v10, s[4:7], s70 offen  lds
  s_add_u32 m0, s66, 13312
  s_add_u32 s70, s65, 106496
  buffer_load_dwordx4 v10, s[4:7], s70 offen  lds
  s_add_u32 m0, s66, 14336
  s_add_u32 s70, s65, 114688
  buffer_load_dwordx4 v10, s[4:7], s70 offen  lds
  s_add_u32 m0, s66, 15360
  s_add_u32 s70, s65, 122880
  buffer_load_dwordx4 v10, s[4:7], s70 offen  lds
  s_barrier
  s_mov_b32 s16, s62
  s_and_b32 s17, s63, 0xffff
  s_mov_b32 s18, 20971520
  s_mov_b32 s19, 0x20000
  s_mov_b32 s20, s58
  s_and_b32 s21, s59, 0xffff
  s_mov_b32 s22, 2097152
  s_mov_b32 s23, 0x20000
  v_lshrrev_b32 v11, 4, v1
  v_bfe_u32 v12, v1, 2, 2
  v_lshl_add_u32 v12, v11, 3, v12
  v_lshlrev_b32 v12, 7, v12
  v_and_b32 v13, 3, v1
  v_lshl_add_u32 v12, v13, 3, v12
  v_add_u32 v12, s66, v12
  v_bfe_u32 v13, v1, 1, 3
  v_lshlrev_b32 v13, 13, v13
  v_and_b32 v14, 1, v1
  v_lshl_add_u32 v13, v14, 6, v13
  v_lshl_add_u32 v16, v11, 4, v13
  s_lshl_b32 s67, s34, 18
  s_lshl_b32 s70, s33, 9
  s_add_u32 s67, s67, s70
  s_add_u32 s67, s67, 8388608
  s_waitcnt vmcnt(12)
  ds_read_b64_tr_b16 v[128:129], v12 offset:0
  ds_read_b64_tr_b16 v[130:131], v12 offset:512
  ds_read_b64_tr_b16 v[132:133], v12 offset:32
  ds_read_b64_tr_b16 v[134:135], v12 offset:544
  ds_read_b64_tr_b16 v[136:137], v12 offset:64
  ds_read_b64_tr_b16 v[138:139], v12 offset:576
  ds_read_b64_tr_b16 v[140:141], v12 offset:96
  ds_read_b64_tr_b16 v[142:143], v12 offset:608
  s_waitcnt lgkmcnt(6)
  s_add_u32 s70, s67, 0
  buffer_store_dwordx4 v[128:131], v16, s[16:19], s70 offen offset:0 sc1
  s_waitcnt lgkmcnt(4)
  s_add_u32 s70, s67, 65536
  buffer_store_dwordx4 v[132:135], v16, s[16:19], s70 offen offset:0 sc1
  s_waitcnt lgkmcnt(2)
  s_add_u32 s70, s67, 131072
  buffer_store_dwordx4 v[136:139], v16, s[16:19], s70 offen offset:0 sc1
  s_waitcnt lgkmcnt(0)
  s_add_u32 s70, s67, 196608
  buffer_store_dwordx4 v[140:143], v16, s[16:19], s70 offen offset:0 sc1
  s_waitcnt vmcnt(12)
  ds_read_b64_tr_b16 v[144:145], v12 offset:4096
  ds_read_b64_tr_b16 v[146:147], v12 offset:4608
  ds_read_b64_tr_b16 v[148:149], v12 offset:4128
  ds_read_b64_tr_b16 v[150:151], v12 offset:4640
  ds_read_b64_tr_b16 v[152:153], v12 offset:4160
  ds_read_b64_tr_b16 v[154:155], v12 offset:4672
  ds_read_b64_tr_b16 v[156:157], v12 offset:4192
  ds_read_b64_tr_b16 v[158:159], v12 offset:4704
  s_waitcnt lgkmcnt(6)
  s_add_u32 s70, s67, 0
  buffer_store_dwordx4 v[144:147], v16, s[16:19], s70 offen offset:128 sc1
  s_waitcnt lgkmcnt(4)
  s_add_u32 s70, s67, 65536
  buffer_store_dwordx4 v[148:151], v16, s[16:19], s70 offen offset:128 sc1
  s_waitcnt lgkmcnt(2)
  s_add_u32 s70, s67, 131072
  buffer_store_dwordx4 v[152:155], v16, s[16:19], s70 offen offset:128 sc1
  s_waitcnt lgkmcnt(0)
  s_add_u32 s70, s67, 196608
  buffer_store_dwordx4 v[156:159], v16, s[16:19], s70 offen offset:128 sc1
  s_waitcnt vmcnt(12)
  ds_read_b64_tr_b16 v[160:161], v12 offset:8192
  ds_read_b64_tr_b16 v[162:163], v12 offset:8704
  ds_read_b64_tr_b16 v[164:165], v12 offset:8224
  ds_read_b64_tr_b16 v[166:167], v12 offset:8736
  ds_read_b64_tr_b16 v[168:169], v12 offset:8256
  ds_read_b64_tr_b16 v[170:171], v12 offset:8768
  ds_read_b64_tr_b16 v[172:173], v12 offset:8288
  ds_read_b64_tr_b16 v[174:175], v12 offset:8800
  s_waitcnt lgkmcnt(6)
  s_add_u32 s70, s67, 0
  buffer_store_dwordx4 v[160:163], v16, s[16:19], s70 offen offset:256 sc1
  s_waitcnt lgkmcnt(4)
  s_add_u32 s70, s67, 65536
  buffer_store_dwordx4 v[164:167], v16, s[16:19], s70 offen offset:256 sc1
  s_waitcnt lgkmcnt(2)
  s_add_u32 s70, s67, 131072
  buffer_store_dwordx4 v[168:171], v16, s[16:19], s70 offen offset:256 sc1
  s_waitcnt lgkmcnt(0)
  s_add_u32 s70, s67, 196608
  buffer_store_dwordx4 v[172:175], v16, s[16:19], s70 offen offset:256 sc1
  s_waitcnt vmcnt(12)
  ds_read_b64_tr_b16 v[176:177], v12 offset:12288
  ds_read_b64_tr_b16 v[178:179], v12 offset:12800
  ds_read_b64_tr_b16 v[180:181], v12 offset:12320
  ds_read_b64_tr_b16 v[182:183], v12 offset:12832
  ds_read_b64_tr_b16 v[184:185], v12 offset:12352
  ds_read_b64_tr_b16 v[186:187], v12 offset:12864
  ds_read_b64_tr_b16 v[188:189], v12 offset:12384
  ds_read_b64_tr_b16 v[190:191], v12 offset:12896
  s_waitcnt lgkmcnt(6)
  s_add_u32 s70, s67, 0
  buffer_store_dwordx4 v[176:179], v16, s[16:19], s70 offen offset:384 sc1
  s_waitcnt lgkmcnt(4)
  s_add_u32 s70, s67, 65536
  buffer_store_dwordx4 v[180:183], v16, s[16:19], s70 offen offset:384 sc1
  s_waitcnt lgkmcnt(2)
  s_add_u32 s70, s67, 131072
  buffer_store_dwordx4 v[184:187], v16, s[16:19], s70 offen offset:384 sc1
  s_waitcnt lgkmcnt(0)
  s_add_u32 s70, s67, 196608
  buffer_store_dwordx4 v[188:191], v16, s[16:19], s70 offen offset:384 sc1
  s_lshl_b32 s69, s26, 2
  s_add_u32 s69, s69, 162816
  v_mov_b32 v50, s69
  v_and_b32 v51, 3, v1
  v_lshlrev_b32 v51, 2, v51
  v_add_u32 v51, 162816, v51
  s_and_b32 s69, s24, 6
  s_lshl_b32 s69, s69, 1
  s_and_b32 s70, s25, 3
  s_add_u32 s69, s69, s70
  s_and_b32 s70, s24, 1
  s_lshl_b32 s32, s69, 1
  s_add_u32 s32, s32, s70
  s_lshl_b32 s32, s32, 13
  s_add_u32 s32, s32, 13041664
  v_min_u32 v30, 27, v1
  v_lshl_add_u32 v59, v30, 8, s32
  s_mov_b32 s12, s54
  s_and_b32 s13, s55, 0xffff
  s_mov_b32 s14, 1835008
  s_mov_b32 s15, 0x20000
  s_mul_i32 s82, s70, -4608
  s_add_u32 s82, s82, s32
  s_lshr_b32 s83, s26, 1
  s_lshl_b32 s83, s83, 13
  s_add_u32 s82, s82, s83
  s_and_b32 s83, s26, 1
  s_mul_i32 s83, s83, 1792
  s_add_u32 s82, s82, s83
  v_min_u32 v30, 6, v1
  v_lshl_add_u32 v59, v30, 8, s82
  s_mul_i32 s82, s26, 458752
  s_lshr_b32 s83, s25, 2
  s_lshl_b32 s83, s83, 7
  s_add_u32 s82, s82, s83
  s_lshl_b32 s83, s26, 15
  s_lshl_b32 s69, s69, 2
  s_and_b32 s81, s26, 1
  s_add_u32 s69, s69, s81
  s_lshl_b32 s76, s70, 1
  s_add_u32 s76, s76, s69
  s_xor_b32 s80, s76, 1
  s_mul_i32 s80, s80, 112
  s_mul_i32 s81, s76, 112
  s_lshl_b32 s70, s70, 1
  s_lshr_b32 s69, s26, 1
  s_add_u32 s70, s70, s69
  s_mul_i32 s70, s26, 28
  s_add_u32 s80, s80, s70
  s_add_u32 s81, s81, s70
  s_lshl_b32 s80, s80, 10
  s_lshl_b32 s81, s81, 10
  s_lshl_b32 s76, s76, 15
  s_lshr_b32 s70, s25, 2
  s_lshl_b32 s70, s70, 1
  s_add_u32 s70, s70, s69
  s_lshl_b32 s70, s70, 6
  s_add_u32 s76, s76, s70
  v_lshlrev_b32 v54, 4, v1
  s_lshl_b32 s70, s26, 15
  v_add_u32 v58, s70, v54
  v_xor_b32 v63, 0x10000, v58
  s_lshl_b32 s70, s26, 12
  s_add_u32 s70, s70, 131072
  v_add_u32 v49, s70, v54
  v_lshrrev_b32 v31, 5, v1
  v_and_b32 v30, 31, v1
  v_lshlrev_b32 v30, 10, v30
  v_lshl_add_u32 v55, v31, 4, v30
  v_bfe_u32 v32, v1, 2, 2
  v_bfe_u32 v33, v1, 4, 1
  v_bfe_u32 v34, v1, 1, 1
  v_lshl_add_u32 v33, v33, 1, v34
  v_bfe_u32 v34, v1, 3, 1
  v_xor_b32 v34, s69, v34
  v_lshl_add_u32 v33, v34, 2, v33
  v_lshl_add_u32 v32, v31, 2, v32
  v_lshlrev_b32 v32, 7, v32
  v_lshl_add_u32 v32, v33, 4, v32
  v_and_b32 v34, 1, v1
  v_lshl_add_u32 v32, v34, 3, v32
  s_lshl_b32 s69, s69, 16
  v_add_u32 v56, s83, v32
  v_xor_b32 v57, 64, v56
  v_mov_b32 v62, 162880
RW_27:
  ds_read_b64 v[60:61], v62
  s_waitcnt lgkmcnt(0)
  v_cmp_ne_u32 vcc, 1, v61
  s_cbranch_vccz RW_28
  s_sleep 1
  s_branch RW_27
RW_28:
  s_lshl_b32 s68, s34, 4
  s_add_u32 s68, s68, s33
  s_lshl_b32 s65, s68, 8
  s_add_u32 s65, s65, 12713984
  s_waitcnt vmcnt(0)
  v_mov_b32 v52, 0
  s_mov_b64 exec, 1
  buffer_store_dword v60, v52, s[16:19], s65 offen sc1
  s_mov_b64 exec, -1
  v_mov_b32 v52, 8
  ds_write_b32 v50, v52 offset:16
  s_setprio 2
  global_load_dwordx4 v[44:47], v54, s[56:57]
  s_lshl_b32 s68, s24, 4
  s_add_u32 s68, s68, s64
  s_lshl_b32 s65, s68, 14
  s_add_u32 s70, s65, 0
  buffer_load_dwordx4 v[64:67], v54, s[4:7], s70 offen offset:0
  buffer_load_dwordx4 v[68:71], v54, s[4:7], s70 offen offset:1024
  buffer_load_dwordx4 v[72:75], v54, s[4:7], s70 offen offset:2048
  buffer_load_dwordx4 v[76:79], v54, s[4:7], s70 offen offset:3072
  s_add_u32 s70, s65, 4096
  buffer_load_dwordx4 v[80:83], v54, s[4:7], s70 offen offset:0
  buffer_load_dwordx4 v[84:87], v54, s[4:7], s70 offen offset:1024
  buffer_load_dwordx4 v[88:91], v54, s[4:7], s70 offen offset:2048
  buffer_load_dwordx4 v[92:95], v54, s[4:7], s70 offen offset:3072
  s_add_u32 s70, s65, 8192
  buffer_load_dwordx4 v[96:99], v54, s[4:7], s70 offen offset:0
  buffer_load_dwordx4 v[100:103], v54, s[4:7], s70 offen offset:1024
  buffer_load_dwordx4 v[104:107], v54, s[4:7], s70 offen offset:2048
  buffer_load_dwordx4 v[108:111], v54, s[4:7], s70 offen offset:3072
  s_add_u32 s70, s65, 12288
  buffer_load_dwordx4 v[112:115], v54, s[4:7], s70 offen offset:0
  buffer_load_dwordx4 v[116:119], v54, s[4:7], s70 offen offset:1024
  buffer_load_dwordx4 v[120:123], v54, s[4:7], s70 offen offset:2048
  buffer_load_dwordx4 v[124:127], v54, s[4:7], s70 offen offset:3072
  s_waitcnt vmcnt(0)
  v_dot2_f32_bf16 v2, v64, v44, 0
  v_dot2_f32_bf16 v3, v68, v44, 0
  v_dot2_f32_bf16 v4, v72, v44, 0
  v_dot2_f32_bf16 v5, v76, v44, 0
  v_dot2_f32_bf16 v6, v80, v44, 0
  v_dot2_f32_bf16 v7, v84, v44, 0
  v_dot2_f32_bf16 v8, v88, v44, 0
  v_dot2_f32_bf16 v9, v92, v44, 0
  v_dot2_f32_bf16 v10, v96, v44, 0
  v_dot2_f32_bf16 v11, v100, v44, 0
  v_dot2_f32_bf16 v12, v104, v44, 0
  v_dot2_f32_bf16 v13, v108, v44, 0
  v_dot2_f32_bf16 v14, v112, v44, 0
  v_dot2_f32_bf16 v15, v116, v44, 0
  v_dot2_f32_bf16 v16, v120, v44, 0
  v_dot2_f32_bf16 v17, v124, v44, 0
  v_dot2_f32_bf16 v2, v65, v45, v2
  v_dot2_f32_bf16 v3, v69, v45, v3
  v_dot2_f32_bf16 v4, v73, v45, v4
  v_dot2_f32_bf16 v5, v77, v45, v5
  v_dot2_f32_bf16 v6, v81, v45, v6
  v_dot2_f32_bf16 v7, v85, v45, v7
  v_dot2_f32_bf16 v8, v89, v45, v8
  v_dot2_f32_bf16 v9, v93, v45, v9
  v_dot2_f32_bf16 v10, v97, v45, v10
  v_dot2_f32_bf16 v11, v101, v45, v11
  v_dot2_f32_bf16 v12, v105, v45, v12
  v_dot2_f32_bf16 v13, v109, v45, v13
  v_dot2_f32_bf16 v14, v113, v45, v14
  v_dot2_f32_bf16 v15, v117, v45, v15
  v_dot2_f32_bf16 v16, v121, v45, v16
  v_dot2_f32_bf16 v17, v125, v45, v17
  v_dot2_f32_bf16 v2, v66, v46, v2
  v_dot2_f32_bf16 v3, v70, v46, v3
  v_dot2_f32_bf16 v4, v74, v46, v4
  v_dot2_f32_bf16 v5, v78, v46, v5
  v_dot2_f32_bf16 v6, v82, v46, v6
  v_dot2_f32_bf16 v7, v86, v46, v7
  v_dot2_f32_bf16 v8, v90, v46, v8
  v_dot2_f32_bf16 v9, v94, v46, v9
  v_dot2_f32_bf16 v10, v98, v46, v10
  v_dot2_f32_bf16 v11, v102, v46, v11
  v_dot2_f32_bf16 v12, v106, v46, v12
  v_dot2_f32_bf16 v13, v110, v46, v13
  v_dot2_f32_bf16 v14, v114, v46, v14
  v_dot2_f32_bf16 v15, v118, v46, v15
  v_dot2_f32_bf16 v16, v122, v46, v16
  v_dot2_f32_bf16 v17, v126, v46, v17
  v_dot2_f32_bf16 v2, v67, v47, v2
  v_dot2_f32_bf16 v3, v71, v47, v3
  v_dot2_f32_bf16 v4, v75, v47, v4
  v_dot2_f32_bf16 v5, v79, v47, v5
  v_dot2_f32_bf16 v6, v83, v47, v6
  v_dot2_f32_bf16 v7, v87, v47, v7
  v_dot2_f32_bf16 v8, v91, v47, v8
  v_dot2_f32_bf16 v9, v95, v47, v9
  v_dot2_f32_bf16 v10, v99, v47, v10
  v_dot2_f32_bf16 v11, v103, v47, v11
  v_dot2_f32_bf16 v12, v107, v47, v12
  v_dot2_f32_bf16 v13, v111, v47, v13
  v_dot2_f32_bf16 v14, v115, v47, v14
  v_dot2_f32_bf16 v15, v119, v47, v15
  v_dot2_f32_bf16 v16, v123, v47, v16
  v_dot2_f32_bf16 v17, v127, v47, v17
  v_add_f32_dpp v2, v2, v2 row_shr:1 row_mask:0xf bank_mask:0xf bound_ctrl:1
  v_add_f32_dpp v3, v3, v3 row_shr:1 row_mask:0xf bank_mask:0xf bound_ctrl:1
  v_add_f32_dpp v4, v4, v4 row_shr:1 row_mask:0xf bank_mask:0xf bound_ctrl:1
  v_add_f32_dpp v5, v5, v5 row_shr:1 row_mask:0xf bank_mask:0xf bound_ctrl:1
  v_add_f32_dpp v6, v6, v6 row_shr:1 row_mask:0xf bank_mask:0xf bound_ctrl:1
  v_add_f32_dpp v7, v7, v7 row_shr:1 row_mask:0xf bank_mask:0xf bound_ctrl:1
  v_add_f32_dpp v8, v8, v8 row_shr:1 row_mask:0xf bank_mask:0xf bound_ctrl:1
  v_add_f32_dpp v9, v9, v9 row_shr:1 row_mask:0xf bank_mask:0xf bound_ctrl:1
  v_add_f32_dpp v10, v10, v10 row_shr:1 row_mask:0xf bank_mask:0xf bound_ctrl:1
  v_add_f32_dpp v11, v11, v11 row_shr:1 row_mask:0xf bank_mask:0xf bound_ctrl:1
  v_add_f32_dpp v12, v12, v12 row_shr:1 row_mask:0xf bank_mask:0xf bound_ctrl:1
  v_add_f32_dpp v13, v13, v13 row_shr:1 row_mask:0xf bank_mask:0xf bound_ctrl:1
  v_add_f32_dpp v14, v14, v14 row_shr:1 row_mask:0xf bank_mask:0xf bound_ctrl:1
  v_add_f32_dpp v15, v15, v15 row_shr:1 row_mask:0xf bank_mask:0xf bound_ctrl:1
  v_add_f32_dpp v16, v16, v16 row_shr:1 row_mask:0xf bank_mask:0xf bound_ctrl:1
  v_add_f32_dpp v17, v17, v17 row_shr:1 row_mask:0xf bank_mask:0xf bound_ctrl:1
  v_add_f32_dpp v2, v2, v2 row_shr:2 row_mask:0xf bank_mask:0xf bound_ctrl:1
  v_add_f32_dpp v3, v3, v3 row_shr:2 row_mask:0xf bank_mask:0xf bound_ctrl:1
  v_add_f32_dpp v4, v4, v4 row_shr:2 row_mask:0xf bank_mask:0xf bound_ctrl:1
  v_add_f32_dpp v5, v5, v5 row_shr:2 row_mask:0xf bank_mask:0xf bound_ctrl:1
  v_add_f32_dpp v6, v6, v6 row_shr:2 row_mask:0xf bank_mask:0xf bound_ctrl:1
  v_add_f32_dpp v7, v7, v7 row_shr:2 row_mask:0xf bank_mask:0xf bound_ctrl:1
  v_add_f32_dpp v8, v8, v8 row_shr:2 row_mask:0xf bank_mask:0xf bound_ctrl:1
  v_add_f32_dpp v9, v9, v9 row_shr:2 row_mask:0xf bank_mask:0xf bound_ctrl:1
  v_add_f32_dpp v10, v10, v10 row_shr:2 row_mask:0xf bank_mask:0xf bound_ctrl:1
  v_add_f32_dpp v11, v11, v11 row_shr:2 row_mask:0xf bank_mask:0xf bound_ctrl:1
  v_add_f32_dpp v12, v12, v12 row_shr:2 row_mask:0xf bank_mask:0xf bound_ctrl:1
  v_add_f32_dpp v13, v13, v13 row_shr:2 row_mask:0xf bank_mask:0xf bound_ctrl:1
  v_add_f32_dpp v14, v14, v14 row_shr:2 row_mask:0xf bank_mask:0xf bound_ctrl:1
  v_add_f32_dpp v15, v15, v15 row_shr:2 row_mask:0xf bank_mask:0xf bound_ctrl:1
  v_add_f32_dpp v16, v16, v16 row_shr:2 row_mask:0xf bank_mask:0xf bound_ctrl:1
  v_add_f32_dpp v17, v17, v17 row_shr:2 row_mask:0xf bank_mask:0xf bound_ctrl:1
  v_add_f32_dpp v2, v2, v2 row_shr:4 row_mask:0xf bank_mask:0xf bound_ctrl:1
  v_add_f32_dpp v3, v3, v3 row_shr:4 row_mask:0xf bank_mask:0xf bound_ctrl:1
  v_add_f32_dpp v4, v4, v4 row_shr:4 row_mask:0xf bank_mask:0xf bound_ctrl:1
  v_add_f32_dpp v5, v5, v5 row_shr:4 row_mask:0xf bank_mask:0xf bound_ctrl:1
  v_add_f32_dpp v6, v6, v6 row_shr:4 row_mask:0xf bank_mask:0xf bound_ctrl:1
  v_add_f32_dpp v7, v7, v7 row_shr:4 row_mask:0xf bank_mask:0xf bound_ctrl:1
  v_add_f32_dpp v8, v8, v8 row_shr:4 row_mask:0xf bank_mask:0xf bound_ctrl:1
  v_add_f32_dpp v9, v9, v9 row_shr:4 row_mask:0xf bank_mask:0xf bound_ctrl:1
  v_add_f32_dpp v10, v10, v10 row_shr:4 row_mask:0xf bank_mask:0xf bound_ctrl:1
  v_add_f32_dpp v11, v11, v11 row_shr:4 row_mask:0xf bank_mask:0xf bound_ctrl:1
  v_add_f32_dpp v12, v12, v12 row_shr:4 row_mask:0xf bank_mask:0xf bound_ctrl:1
  v_add_f32_dpp v13, v13, v13 row_shr:4 row_mask:0xf bank_mask:0xf bound_ctrl:1
  v_add_f32_dpp v14, v14, v14 row_shr:4 row_mask:0xf bank_mask:0xf bound_ctrl:1
  v_add_f32_dpp v15, v15, v15 row_shr:4 row_mask:0xf bank_mask:0xf bound_ctrl:1
  v_add_f32_dpp v16, v16, v16 row_shr:4 row_mask:0xf bank_mask:0xf bound_ctrl:1
  v_add_f32_dpp v17, v17, v17 row_shr:4 row_mask:0xf bank_mask:0xf bound_ctrl:1
  v_add_f32_dpp v2, v2, v2 row_shr:8 row_mask:0xf bank_mask:0xf bound_ctrl:1
  v_add_f32_dpp v3, v3, v3 row_shr:8 row_mask:0xf bank_mask:0xf bound_ctrl:1
  v_add_f32_dpp v4, v4, v4 row_shr:8 row_mask:0xf bank_mask:0xf bound_ctrl:1
  v_add_f32_dpp v5, v5, v5 row_shr:8 row_mask:0xf bank_mask:0xf bound_ctrl:1
  v_add_f32_dpp v6, v6, v6 row_shr:8 row_mask:0xf bank_mask:0xf bound_ctrl:1
  v_add_f32_dpp v7, v7, v7 row_shr:8 row_mask:0xf bank_mask:0xf bound_ctrl:1
  v_add_f32_dpp v8, v8, v8 row_shr:8 row_mask:0xf bank_mask:0xf bound_ctrl:1
  v_add_f32_dpp v9, v9, v9 row_shr:8 row_mask:0xf bank_mask:0xf bound_ctrl:1
  v_add_f32_dpp v10, v10, v10 row_shr:8 row_mask:0xf bank_mask:0xf bound_ctrl:1
  v_add_f32_dpp v11, v11, v11 row_shr:8 row_mask:0xf bank_mask:0xf bound_ctrl:1
  v_add_f32_dpp v12, v12, v12 row_shr:8 row_mask:0xf bank_mask:0xf bound_ctrl:1
  v_add_f32_dpp v13, v13, v13 row_shr:8 row_mask:0xf bank_mask:0xf bound_ctrl:1
  v_add_f32_dpp v14, v14, v14 row_shr:8 row_mask:0xf bank_mask:0xf bound_ctrl:1
  v_add_f32_dpp v15, v15, v15 row_shr:8 row_mask:0xf bank_mask:0xf bound_ctrl:1
  v_add_f32_dpp v16, v16, v16 row_shr:8 row_mask:0xf bank_mask:0xf bound_ctrl:1
  v_add_f32_dpp v17, v17, v17 row_shr:8 row_mask:0xf bank_mask:0xf bound_ctrl:1
  v_add_f32_dpp v2, v2, v2 row_bcast:15 row_mask:0xa bank_mask:0xf
  v_add_f32_dpp v3, v3, v3 row_bcast:15 row_mask:0xa bank_mask:0xf
  v_add_f32_dpp v4, v4, v4 row_bcast:15 row_mask:0xa bank_mask:0xf
  v_add_f32_dpp v5, v5, v5 row_bcast:15 row_mask:0xa bank_mask:0xf
  v_add_f32_dpp v6, v6, v6 row_bcast:15 row_mask:0xa bank_mask:0xf
  v_add_f32_dpp v7, v7, v7 row_bcast:15 row_mask:0xa bank_mask:0xf
  v_add_f32_dpp v8, v8, v8 row_bcast:15 row_mask:0xa bank_mask:0xf
  v_add_f32_dpp v9, v9, v9 row_bcast:15 row_mask:0xa bank_mask:0xf
  v_add_f32_dpp v10, v10, v10 row_bcast:15 row_mask:0xa bank_mask:0xf
  v_add_f32_dpp v11, v11, v11 row_bcast:15 row_mask:0xa bank_mask:0xf
  v_add_f32_dpp v12, v12, v12 row_bcast:15 row_mask:0xa bank_mask:0xf
  v_add_f32_dpp v13, v13, v13 row_bcast:15 row_mask:0xa bank_mask:0xf
  v_add_f32_dpp v14, v14, v14 row_bcast:15 row_mask:0xa bank_mask:0xf
  v_add_f32_dpp v15, v15, v15 row_bcast:15 row_mask:0xa bank_mask:0xf
  v_add_f32_dpp v16, v16, v16 row_bcast:15 row_mask:0xa bank_mask:0xf
  v_add_f32_dpp v17, v17, v17 row_bcast:15 row_mask:0xa bank_mask:0xf
  v_add_f32_dpp v2, v2, v2 row_bcast:31 row_mask:0xc bank_mask:0xf
  v_add_f32_dpp v3, v3, v3 row_bcast:31 row_mask:0xc bank_mask:0xf
  v_add_f32_dpp v4, v4, v4 row_bcast:31 row_mask:0xc bank_mask:0xf
  v_add_f32_dpp v5, v5, v5 row_bcast:31 row_mask:0xc bank_mask:0xf
  v_add_f32_dpp v6, v6, v6 row_bcast:31 row_mask:0xc bank_mask:0xf
  v_add_f32_dpp v7, v7, v7 row_bcast:31 row_mask:0xc bank_mask:0xf
  v_add_f32_dpp v8, v8, v8 row_bcast:31 row_mask:0xc bank_mask:0xf
  v_add_f32_dpp v9, v9, v9 row_bcast:31 row_mask:0xc bank_mask:0xf
  v_add_f32_dpp v10, v10, v10 row_bcast:31 row_mask:0xc bank_mask:0xf
  v_add_f32_dpp v11, v11, v11 row_bcast:31 row_mask:0xc bank_mask:0xf
  v_add_f32_dpp v12, v12, v12 row_bcast:31 row_mask:0xc bank_mask:0xf
  v_add_f32_dpp v13, v13, v13 row_bcast:31 row_mask:0xc bank_mask:0xf
  v_add_f32_dpp v14, v14, v14 row_bcast:31 row_mask:0xc bank_mask:0xf
  v_add_f32_dpp v15, v15, v15 row_bcast:31 row_mask:0xc bank_mask:0xf
  v_add_f32_dpp v16, v16, v16 row_bcast:31 row_mask:0xc bank_mask:0xf
  v_add_f32_dpp v17, v17, v17 row_bcast:31 row_mask:0xc bank_mask:0xf
  v_mov_b32 v20, 0
  v_readlane_b32 s38, v2, 63
  v_readlane_b32 s39, v3, 63
  v_readlane_b32 s40, v4, 63
  v_readlane_b32 s41, v5, 63
  v_readlane_b32 s42, v6, 63
  v_readlane_b32 s43, v7, 63
  v_readlane_b32 s44, v8, 63
  v_readlane_b32 s45, v9, 63
  s_nop 3
  v_writelane_b32 v20, s38, 0
  v_writelane_b32 v20, s39, 1
  v_writelane_b32 v20, s40, 2
  v_writelane_b32 v20, s41, 3
  v_writelane_b32 v20, s42, 4
  v_writelane_b32 v20, s43, 5
  v_writelane_b32 v20, s44, 6
  v_writelane_b32 v20, s45, 7
  v_readlane_b32 s38, v10, 63
  v_readlane_b32 s39, v11, 63
  v_readlane_b32 s40, v12, 63
  v_readlane_b32 s41, v13, 63
  v_readlane_b32 s42, v14, 63
  v_readlane_b32 s43, v15, 63
  v_readlane_b32 s44, v16, 63
  v_readlane_b32 s45, v17, 63
  s_nop 3
  v_writelane_b32 v20, s38, 8
  v_writelane_b32 v20, s39, 9
  v_writelane_b32 v20, s40, 10
  v_writelane_b32 v20, s41, 11
  v_writelane_b32 v20, s42, 12
  v_writelane_b32 v20, s43, 13
  v_writelane_b32 v20, s44, 14
  v_writelane_b32 v20, s45, 15
  v_cvt_pk_bf16_f32 v20, v20, v20
  v_lshlrev_b32 v20, 16, v20
  v_mul_f32 v20, 0xbfb8aa3b, v20
  v_exp_f32 v20, v20
  s_nop 0
  v_add_f32 v20, 1.0, v20
  v_rcp_f32 v20, v20
  s_nop 0
  v_cvt_pk_bf16_f32 v22, v20, v20
  v_lshlrev_b32 v22, 16, v22
  v_sub_f32 v23, 1.0, v22
  v_cvt_pk_bf16_f32 v23, v23, v23
  v_lshlrev_b32 v23, 16, v23
  v_lshlrev_b32 v21, 3, v1
  s_lshl_b32 s65, s68, 7
  s_add_u32 s65, s65, 12582912
  s_mov_b64 exec, 0xffff
  buffer_store_dwordx2 v[22:23], v21, s[16:19], s65 offen sc1
  s_mov_b64 exec, -1
  s_lshl_b32 s65, s68, 8
  s_add_u32 s65, s65, 12746752
  s_waitcnt vmcnt(0)
  v_mov_b32 v52, 0
  s_mov_b64 exec, 1
  buffer_store_dword v60, v52, s[16:19], s65 offen sc1
  s_mov_b64 exec, -1
  s_branch K_G2
K_SSM:
  s_setprio 3
  s_sub_u32 s26, s26, 4
  s_lshl_b32 s64, s24, 5
  s_add_u32 s64, s64, s25
  s_lshr_b32 s65, s26, 1
  s_and_b32 s66, s26, 1
  s_lshl_b32 s67, s26, 2
  s_add_u32 s67, s67, 162848
  v_mov_b32 v22, s67
  v_and_b32 v23, 3, v1
  v_lshlrev_b32 v23, 2, v23
  v_add_u32 v23, 162848, v23
  v_min_u32 v8, 35, v1
  v_lshlrev_b32 v8, 3, v8
  v_add_u32 v8, 158016, v8
  v_mov_b32 v10, 0
  v_mov_b32 v11, 0
  ds_write_b64 v8, v[10:11]
  s_getreg_b32 s31, hwreg(HW_REG_XCC_ID)
  s_lshl_b32 s67, s64, 9
  s_lshl_b32 s68, s26, 7
  s_add_u32 s67, s67, s68
  v_lshl_add_u32 v6, v1, 1, s67
  s_lshl_b32 s67, s64, 2
  s_waitcnt lgkmcnt(0)
  global_load_ushort v2, v6, s[38:39]
  global_load_ushort v3, v6, s[40:41]
  global_load_ushort v4, v6, s[42:43]
  global_load_ushort v5, v6, s[44:45]
  s_load_dword s69, s[46:47], s67
  s_load_dword s70, s[48:49], s67
  s_add_u32 s28, s62, 13565952
  s_addc_u32 s29, s63, 0
  s_cmp_eq_u32 s26, 1
  s_cbranch_scc0 S_NT
  s_load_dword s30, s[28:29], 0
S_NT:
  s_barrier
  s_mov_b32 s12, s54
  s_and_b32 s13, s55, 0xffff
  s_mov_b32 s14, 1835008
  s_mov_b32 s15, 0x20000
  s_lshr_b32 s67, s24, 1
  s_and_b32 s68, s24, 1
  s_lshl_b32 s68, s68, 2
  s_add_u32 s67, s67, s68
  s_lshl_b32 s67, s67, 5
  s_add_u32 s67, s67, s25
  s_mul_i32 s67, s67, 7168
  s_mul_i32 s68, s26, 1792
  s_add_u32 s67, s67, s68
  v_min_u32 v39, 13, v1
  v_lshlrev_b32 v39, 7, v39
  buffer_load_dword v39, v39, s[12:15], s67 offen
  s_mul_i32 s71, s26, 4352
  s_add_u32 s71, s71, 140288
  v_lshl_add_u32 v26, v1, 2, s71
  v_and_b32 v8, 15, v1
  v_lshrrev_b32 v9, 5, v1
  v_lshl_add_u32 v9, v9, 4, s71
  v_mov_b32 v10, 272
  v_mad_u32_u24 v27, v8, v10, v9
  v_and_b32 v11, 7, v1
  v_lshlrev_b32 v11, 2, v11
  v_mov_b32 v12, 0xcbaaa988
  v_lshrrev_b32 v11, v11, v12
  v_and_b32 v11, 15, v11
  v_and_b32 v12, 24, v1
  v_cmp_eq_u32 vcc, 8, v12
  s_mov_b32 s72, 0x0000ffff
  s_mov_b32 s73, 0x0000ffff
  s_mov_b32 s74, 0xffff0000
  s_mov_b32 s75, 0xffff0000
  v_cndmask_b32 v11, v8, v11, vcc
  v_mad_u32_u24 v28, v11, v10, v9
  s_mov_b32 s4, s36
  s_and_b32 s5, s37, 0xffff
  s_mov_b32 s6, 2097152
  s_mov_b32 s7, 0x20000
  s_mov_b32 s8, s52
  s_and_b32 s9, s53, 0xffff
  s_mov_b32 s10, 1835008
  s_mov_b32 s11, 0x20000
  s_mov_b32 s12, s54
  s_and_b32 s13, s55, 0xffff
  s_mov_b32 s14, 1835008
  s_mov_b32 s15, 0x20000
  s_mov_b32 s16, s62
  s_and_b32 s17, s63, 0xffff
  s_mov_b32 s18, 20971520
  s_mov_b32 s19, 0x20000
  s_and_b32 s76, s25, 3
  s_and_b32 s82, s24, 6
  s_lshl_b32 s82, s82, 1
  s_add_u32 s76, s76, s82
  s_lshl_b32 s76, s76, 1
  s_add_u32 s76, s76, s66
  s_and_b32 s82, s24, 1
  s_lshl_b32 s76, s76, 16
  s_mul_i32 s77, s82, 7
  s_lshr_b32 s83, s25, 2
  s_add_u32 s77, s77, s83
  s_lshl_b32 s77, s77, 8
  s_lshr_b32 s80, s25, 2
  s_lshl_b32 s80, s80, 7
  s_mul_i32 s83, s66, 114688
  s_add_u32 s77, s77, s83
  s_lshl_b32 s78, s66, 13
  s_mul_i32 s82, s82, 0
  s_add_u32 s80, s80, s82
  s_mul_i32 s82, s66, 114688
  s_add_u32 s80, s80, s82
  s_mul_i32 s81, s66, 14336
  s_mov_b32 s79, 0
  s_lshr_b32 s82, s24, 1
  s_mul_i32 s82, s82, 2
  s_add_u32 s79, s79, s82
  s_and_b32 s82, s24, 1
  s_mul_i32 s82, s82, 1
  s_add_u32 s79, s79, s82
  v_lshrrev_b32 v34, 3, v1
  v_and_b32 v35, 7, v1
  v_lshrrev_b32 v36, 4, v1
  v_xor_b32 v37, v35, v36
  v_xor_b32 v38, 4, v37
  v_lshlrev_b32 v34, 10, v34
  v_lshl_add_u32 v16, v37, 4, v34
  v_lshl_add_u32 v17, v38, 4, v34
  v_add_u32 v17, 7168, v17
  v_add_u32 v18, 14336, v16
  v_add_u32 v19, 14336, v17
  v_and_b32 v37, 1, v36
  v_lshlrev_b32 v37, 2, v37
  v_xor_b32 v37, v35, v37
  v_lshl_add_u32 v60, v37, 4, v34
  v_add_u32 v61, 7168, v60
  v_and_b32 v35, 15, v1
  v_lshlrev_b32 v37, 2, v36
  v_xor_b32 v35, v35, v37
  v_mul_u32_u24 v37, 3584, v36
  v_lshl_add_u32 v56, v35, 4, v37
  v_add_u32 v57, 13312, v56
  v_add_u32 v58, 26624, v56
  v_add_u32 v59, 39936, v56
  s_lshl_b32 s82, s66, 3
  s_add_u32 s82, s82, 162864
  s_cmp_eq_u32 s65, 1
  s_cselect_b32 s82, s82, 162944
  v_mov_b32 v62, s82
  v_subrev_u32 v63, 16, v23
  s_waitcnt lgkmcnt(0)
  s_lshl_b32 s67, s65, 4
  s_lshr_b32 s69, s69, s67
  s_lshl_b32 s69, s69, 16
  s_lshr_b32 s70, s70, s67
  s_lshl_b32 s70, s70, 16
  v_mov_b32 v10, 0x3fb8aa3b
  v_mul_f32 v8, s69, v10
  v_exp_f32 v8, v8
  s_waitcnt vmcnt(1)
  s_cmp_eq_u32 s26, 1
  s_cbranch_scc0 S_NP
  s_mul_i32 s30, s30, 0x9e3779a1
  s_add_u32 s30, s30, 0x7f4a7c10
  s_and_b32 s30, s30, -16
  s_and_b32 s31, s31, 15
  s_or_b32 s31, s31, s30
  v_mov_b32 v32, s30
  v_mov_b32 v33, 1
  v_mov_b32 v34, 162880
  ds_write_b64 v34, v[32:33]
  v_mov_b32 v35, s31
  s_lshl_b32 s28, s2, 8
  s_add_u32 s28, s28, 12648448
  v_mov_b32 v36, 0
  s_mov_b64 exec, 1
  buffer_store_dword v35, v36, s[16:19], s28 offen sc1
  s_mov_b64 exec, -1
S_NP:
  v_lshlrev_b32 v2, 16, v2
  v_lshlrev_b32 v3, 16, v3
  v_lshlrev_b32 v4, 16, v4
  v_lshlrev_b32 v5, 16, v5
  v_mul_f32 v2, v10, v2
  v_exp_f32 v2, v2
  v_cvt_pk_bf16_f32 v8, v8, v8
  v_lshlrev_b32 v8, 16, v8
  v_cvt_pk_bf16_f32 v2, v2, v2
  v_lshlrev_b32 v2, 16, v2
  v_mul_f32 v2, v2, v8
  v_mul_f32 v3, v3, v8
  v_mul_f32 v2, 0xbfb8aa3b, v2
  v_mul_f32 v3, 0x3e22f983, v3
  v_add_f32 v8, v8, v8
  v_mul_f32 v134, v4, v8
  v_mul_f32 v135, v5, v8
  v_mul_f32 v10, 0x41000000, v2
  v_mul_f32 v11, 0x41000000, v3
  v_mul_f32 v12, 0x43800000, v2
  v_mul_f32 v13, 0x43800000, v3
  v_fract_f32 v11, v11
  v_fract_f32 v3, v3
  v_fract_f32 v13, v13
  v_exp_f32 v10, v10
  v_cos_f32 v130, v11
  v_sin_f32 v131, v11
  v_exp_f32 v2, v2
  v_cos_f32 v128, v3
  v_sin_f32 v129, v3
  v_exp_f32 v12, v12
  v_cos_f32 v132, v13
  v_sin_f32 v133, v13
  v_pk_mul_f32 v[130:131], v[130:131], v[10:11] op_sel:[0,0] op_sel_hi:[1,0]
  v_pk_mul_f32 v[128:129], v[128:129], v[2:3] op_sel:[0,0] op_sel_hi:[1,0]
  v_pk_mul_f32 v[132:133], v[132:133], v[12:13] op_sel:[0,0] op_sel_hi:[1,0]
  v_add_u32 v212, 1088, v26
  v_add_u32 v213, 2176, v26
  v_add_u32 v214, 3264, v26
  v_mov_b32 v140, 1.0
  v_mov_b32 v141, 0
  v_mov_b32 v142, v130
  v_mov_b32 v143, v131
  v_pk_mul_f32 v[144:145], v[130:131], v[130:131] op_sel:[0,0] op_sel_hi:[1,0]
  v_pk_mul_f32 v[136:137], v[128:129], v[128:129] op_sel:[0,0] op_sel_hi:[1,0]
  v_pk_mul_f32 v[162:163], v[134:135], v[128:129] op_sel:[0,0] op_sel_hi:[1,0]
  v_pk_mul_f32 v[176:177], v[134:135], v[130:131] op_sel:[0,0] op_sel_hi:[1,0]
  v_pk_fma_f32 v[144:145], v[130:131], v[130:131], v[144:145] op_sel:[1,1,0] op_sel_hi:[0,1,1] neg_lo:[1,0,0]
  v_pk_fma_f32 v[136:137], v[128:129], v[128:129], v[136:137] op_sel:[1,1,0] op_sel_hi:[0,1,1] neg_lo:[1,0,0]
  v_pk_fma_f32 v[162:163], v[134:135], v[128:129], v[162:163] op_sel:[1,1,0] op_sel_hi:[0,1,1] neg_lo:[1,0,0]
  v_pk_fma_f32 v[176:177], v[134:135], v[130:131], v[176:177] op_sel:[1,1,0] op_sel_hi:[0,1,1] neg_lo:[1,0,0]
  v_pk_mul_f32 v[146:147], v[144:145], v[130:131] op_sel:[0,0] op_sel_hi:[1,0]
  v_pk_mul_f32 v[156:157], v[144:145], v[144:145] op_sel:[0,0] op_sel_hi:[1,0]
  v_pk_mul_f32 v[138:139], v[136:137], v[136:137] op_sel:[0,0] op_sel_hi:[1,0]
  v_pk_mul_f32 v[164:165], v[134:135], v[136:137] op_sel:[0,0] op_sel_hi:[1,0]
  v_pk_mul_f32 v[166:167], v[162:163], v[136:137] op_sel:[0,0] op_sel_hi:[1,0]
  v_pk_fma_f32 v[146:147], v[144:145], v[130:131], v[146:147] op_sel:[1,1,0] op_sel_hi:[0,1,1] neg_lo:[1,0,0]
  v_pk_fma_f32 v[156:157], v[144:145], v[144:145], v[156:157] op_sel:[1,1,0] op_sel_hi:[0,1,1] neg_lo:[1,0,0]
  v_pk_fma_f32 v[138:139], v[136:137], v[136:137], v[138:139] op_sel:[1,1,0] op_sel_hi:[0,1,1] neg_lo:[1,0,0]
  v_pk_fma_f32 v[164:165], v[134:135], v[136:137], v[164:165] op_sel:[1,1,0] op_sel_hi:[0,1,1] neg_lo:[1,0,0]
  v_pk_fma_f32 v[166:167], v[162:163], v[136:137], v[166:167] op_sel:[1,1,0] op_sel_hi:[0,1,1] neg_lo:[1,0,0]
  v_xor_b32 v208, 0x80000000, v139
  v_xor_b32 v209, 0x80000000, v133
  v_cvt_pk_bf16_f32 v200, v140, v141
  v_cvt_pk_bf16_f32 v201, v142, v143
  v_cvt_pk_bf16_f32 v202, v144, v145
  v_cvt_pk_bf16_f32 v203, v146, v147
  v_pk_mul_f32 v[148:149], v[140:141], v[156:157] op_sel:[0,0] op_sel_hi:[1,0]
  v_pk_mul_f32 v[150:151], v[142:143], v[156:157] op_sel:[0,0] op_sel_hi:[1,0]
  v_pk_mul_f32 v[152:153], v[144:145], v[156:157] op_sel:[0,0] op_sel_hi:[1,0]
  ds_write2_b32 v26, v200, v201 offset0:0 offset1:68
  v_pk_mul_f32 v[154:155], v[146:147], v[156:157] op_sel:[0,0] op_sel_hi:[1,0]
  v_pk_fma_f32 v[148:149], v[140:141], v[156:157], v[148:149] op_sel:[1,1,0] op_sel_hi:[0,1,1] neg_lo:[1,0,0]
  v_pk_fma_f32 v[150:151], v[142:143], v[156:157], v[150:151] op_sel:[1,1,0] op_sel_hi:[0,1,1] neg_lo:[1,0,0]
  ds_write2_b32 v26, v202, v203 offset0:136 offset1:204
  v_pk_fma_f32 v[152:153], v[144:145], v[156:157], v[152:153] op_sel:[1,1,0] op_sel_hi:[0,1,1] neg_lo:[1,0,0]
  v_pk_fma_f32 v[154:155], v[146:147], v[156:157], v[154:155] op_sel:[1,1,0] op_sel_hi:[0,1,1] neg_lo:[1,0,0]
  v_cvt_pk_bf16_f32 v204, v148, v149
  v_cvt_pk_bf16_f32 v205, v150, v151
  v_cvt_pk_bf16_f32 v206, v152, v153
  v_cvt_pk_bf16_f32 v207, v154, v155
  v_pk_mul_f32 v[140:141], v[148:149], v[156:157] op_sel:[0,0] op_sel_hi:[1,0]
  v_pk_mul_f32 v[142:143], v[150:151], v[156:157] op_sel:[0,0] op_sel_hi:[1,0]
  v_pk_mul_f32 v[144:145], v[152:153], v[156:157] op_sel:[0,0] op_sel_hi:[1,0]
  ds_write2_b32 v212, v204, v205 offset0:0 offset1:68
  v_pk_mul_f32 v[146:147], v[154:155], v[156:157] op_sel:[0,0] op_sel_hi:[1,0]
  v_pk_fma_f32 v[140:141], v[148:149], v[156:157], v[140:141] op_sel:[1,1,0] op_sel_hi:[0,1,1] neg_lo:[1,0,0]
  v_pk_fma_f32 v[142:143], v[150:151], v[156:157], v[142:143] op_sel:[1,1,0] op_sel_hi:[0,1,1] neg_lo:[1,0,0]
  ds_write2_b32 v212, v206, v207 offset0:136 offset1:204
  v_pk_fma_f32 v[144:145], v[152:153], v[156:157], v[144:145] op_sel:[1,1,0] op_sel_hi:[0,1,1] neg_lo:[1,0,0]
  v_pk_fma_f32 v[146:147], v[154:155], v[156:157], v[146:147] op_sel:[1,1,0] op_sel_hi:[0,1,1] neg_lo:[1,0,0]
  v_cvt_pk_bf16_f32 v200, v140, v141
  v_cvt_pk_bf16_f32 v201, v142, v143
  v_cvt_pk_bf16_f32 v202, v144, v145
  v_cvt_pk_bf16_f32 v203, v146, v147
  v_pk_mul_f32 v[148:149], v[140:141], v[156:157] op_sel:[0,0] op_sel_hi:[1,0]
  v_pk_mul_f32 v[150:151], v[142:143], v[156:157] op_sel:[0,0] op_sel_hi:[1,0]
  v_pk_mul_f32 v[152:153], v[144:145], v[156:157] op_sel:[0,0] op_sel_hi:[1,0]
  ds_write2_b32 v213, v200, v201 offset0:0 offset1:68
  v_pk_mul_f32 v[154:155], v[146:147], v[156:157] op_sel:[0,0] op_sel_hi:[1,0]
  v_pk_fma_f32 v[148:149], v[140:141], v[156:157], v[148:149] op_sel:[1,1,0] op_sel_hi:[0,1,1] neg_lo:[1,0,0]
  v_pk_fma_f32 v[150:151], v[142:143], v[156:157], v[150:151] op_sel:[1,1,0] op_sel_hi:[0,1,1] neg_lo:[1,0,0]
  ds_write2_b32 v213, v202, v203 offset0:136 offset1:204
  v_pk_fma_f32 v[152:153], v[144:145], v[156:157], v[152:153] op_sel:[1,1,0] op_sel_hi:[0,1,1] neg_lo:[1,0,0]
  v_pk_fma_f32 v[154:155], v[146:147], v[156:157], v[154:155] op_sel:[1,1,0] op_sel_hi:[0,1,1] neg_lo:[1,0,0]
  v_cvt_pk_bf16_f32 v204, v148, v149
  v_cvt_pk_bf16_f32 v205, v150, v151
  v_cvt_pk_bf16_f32 v206, v152, v153
  v_cvt_pk_bf16_f32 v207, v154, v155
  v_pk_mul_f32 v[140:141], v[148:149], v[156:157] op_sel:[0,0] op_sel_hi:[1,0]
  v_pk_mul_f32 v[142:143], v[150:151], v[156:157] op_sel:[0,0] op_sel_hi:[1,0]
  v_pk_mul_f32 v[144:145], v[152:153], v[156:157] op_sel:[0,0] op_sel_hi:[1,0]
  ds_write2_b32 v214, v204, v205 offset0:0 offset1:68
  v_pk_mul_f32 v[146:147], v[154:155], v[156:157] op_sel:[0,0] op_sel_hi:[1,0]
  v_pk_fma_f32 v[140:141], v[148:149], v[156:157], v[140:141] op_sel:[1,1,0] op_sel_hi:[0,1,1] neg_lo:[1,0,0]
  v_pk_fma_f32 v[142:143], v[150:151], v[156:157], v[142:143] op_sel:[1,1,0] op_sel_hi:[0,1,1] neg_lo:[1,0,0]
  ds_write2_b32 v214, v206, v207 offset0:136 offset1:204
  v_pk_fma_f32 v[144:145], v[152:153], v[156:157], v[144:145] op_sel:[1,1,0] op_sel_hi:[0,1,1] neg_lo:[1,0,0]
  v_pk_fma_f32 v[146:147], v[154:155], v[156:157], v[146:147] op_sel:[1,1,0] op_sel_hi:[0,1,1] neg_lo:[1,0,0]
  s_mov_b64 exec, s[72:73]
  ds_read_b128 v[64:67], v27 offset:0
  ds_read_b128 v[68:71], v27 offset:32
  ds_read_b128 v[72:75], v27 offset:64
  ds_read_b128 v[76:79], v27 offset:96
  ds_read_b128 v[80:83], v27 offset:128
  ds_read_b128 v[84:87], v27 offset:160
  ds_read_b128 v[88:91], v27 offset:192
  ds_read_b128 v[92:95], v27 offset:224
  s_mov_b64 exec, -1
  v_cvt_pk_bf16_f32 v200, v140, v141
  v_cvt_pk_bf16_f32 v201, v142, v143
  v_cvt_pk_bf16_f32 v202, v144, v145
  v_cvt_pk_bf16_f32 v203, v146, v147
  v_pk_mul_f32 v[148:149], v[140:141], v[156:157] op_sel:[0,0] op_sel_hi:[1,0]
  v_pk_mul_f32 v[150:151], v[142:143], v[156:157] op_sel:[0,0] op_sel_hi:[1,0]
  v_pk_mul_f32 v[152:153], v[144:145], v[156:157] op_sel:[0,0] op_sel_hi:[1,0]
  ds_write2_b32 v26, v200, v201 offset0:0 offset1:68
  v_pk_mul_f32 v[154:155], v[146:147], v[156:157] op_sel:[0,0] op_sel_hi:[1,0]
  v_pk_fma_f32 v[148:149], v[140:141], v[156:157], v[148:149] op_sel:[1,1,0] op_sel_hi:[0,1,1] neg_lo:[1,0,0]
  v_pk_fma_f32 v[150:151], v[142:143], v[156:157], v[150:151] op_sel:[1,1,0] op_sel_hi:[0,1,1] neg_lo:[1,0,0]
  ds_write2_b32 v26, v202, v203 offset0:136 offset1:204
  v_pk_fma_f32 v[152:153], v[144:145], v[156:157], v[152:153] op_sel:[1,1,0] op_sel_hi:[0,1,1] neg_lo:[1,0,0]
  v_pk_fma_f32 v[154:155], v[146:147], v[156:157], v[154:155] op_sel:[1,1,0] op_sel_hi:[0,1,1] neg_lo:[1,0,0]
  v_cvt_pk_bf16_f32 v204, v148, v149
  v_cvt_pk_bf16_f32 v205, v150, v151
  v_cvt_pk_bf16_f32 v206, v152, v153
  v_cvt_pk_bf16_f32 v207, v154, v155
  v_pk_mul_f32 v[140:141], v[148:149], v[156:157] op_sel:[0,0] op_sel_hi:[1,0]
  v_pk_mul_f32 v[142:143], v[150:151], v[156:157] op_sel:[0,0] op_sel_hi:[1,0]
  v_pk_mul_f32 v[144:145], v[152:153], v[156:157] op_sel:[0,0] op_sel_hi:[1,0]
  ds_write2_b32 v212, v204, v205 offset0:0 offset1:68
  v_pk_mul_f32 v[146:147], v[154:155], v[156:157] op_sel:[0,0] op_sel_hi:[1,0]
  v_pk_fma_f32 v[140:141], v[148:149], v[156:157], v[140:141] op_sel:[1,1,0] op_sel_hi:[0,1,1] neg_lo:[1,0,0]
  v_pk_fma_f32 v[142:143], v[150:151], v[156:157], v[142:143] op_sel:[1,1,0] op_sel_hi:[0,1,1] neg_lo:[1,0,0]
  ds_write2_b32 v212, v206, v207 offset0:136 offset1:204
  v_pk_fma_f32 v[144:145], v[152:153], v[156:157], v[144:145] op_sel:[1,1,0] op_sel_hi:[0,1,1] neg_lo:[1,0,0]
  v_pk_fma_f32 v[146:147], v[154:155], v[156:157], v[146:147] op_sel:[1,1,0] op_sel_hi:[0,1,1] neg_lo:[1,0,0]
  v_cvt_pk_bf16_f32 v200, v140, v141
  v_cvt_pk_bf16_f32 v201, v142, v143
  v_cvt_pk_bf16_f32 v202, v144, v145
  v_cvt_pk_bf16_f32 v203, v146, v147
  v_pk_mul_f32 v[148:149], v[140:141], v[156:157] op_sel:[0,0] op_sel_hi:[1,0]
  v_pk_mul_f32 v[150:151], v[142:143], v[156:157] op_sel:[0,0] op_sel_hi:[1,0]
  v_pk_mul_f32 v[152:153], v[144:145], v[156:157] op_sel:[0,0] op_sel_hi:[1,0]
  ds_write2_b32 v213, v200, v201 offset0:0 offset1:68
  v_pk_mul_f32 v[154:155], v[146:147], v[156:157] op_sel:[0,0] op_sel_hi:[1,0]
  v_pk_fma_f32 v[148:149], v[140:141], v[156:157], v[148:149] op_sel:[1,1,0] op_sel_hi:[0,1,1] neg_lo:[1,0,0]
  v_pk_fma_f32 v[150:151], v[142:143], v[156:157], v[150:151] op_sel:[1,1,0] op_sel_hi:[0,1,1] neg_lo:[1,0,0]
  ds_write2_b32 v213, v202, v203 offset0:136 offset1:204
  v_pk_fma_f32 v[152:153], v[144:145], v[156:157], v[152:153] op_sel:[1,1,0] op_sel_hi:[0,1,1] neg_lo:[1,0,0]
  v_pk_fma_f32 v[154:155], v[146:147], v[156:157], v[154:155] op_sel:[1,1,0] op_sel_hi:[0,1,1] neg_lo:[1,0,0]
  v_cvt_pk_bf16_f32 v204, v148, v149
  v_cvt_pk_bf16_f32 v205, v150, v151
  v_cvt_pk_bf16_f32 v206, v152, v153
  v_cvt_pk_bf16_f32 v207, v154, v155
  v_mul_f32 v168, v134, v138
  v_mul_f32 v169, v134, v139
  v_mul_f32 v170, v162, v138
  v_mul_f32 v171, v162, v139
  v_mul_f32 v172, v164, v138
  v_mul_f32 v173, v164, v139
  ds_write2_b32 v214, v204, v205 offset0:0 offset1:68
  v_mul_f32 v174, v166, v138
  v_mul_f32 v175, v166, v139
  v_fmac_f32 v168, v135, v208
  v_fmac_f32 v169, v135, v138
  v_fmac_f32 v170, v163, v208
  ds_write2_b32 v214, v206, v207 offset0:136 offset1:204
  v_fmac_f32 v171, v163, v138
  v_fmac_f32 v172, v165, v208
  v_fmac_f32 v173, v165, v138
  v_fmac_f32 v174, v167, v208
  v_fmac_f32 v175, v167, v138
  s_mov_b64 exec, s[74:75]
  ds_read_b128 v[64:67], v27 offset:0
  ds_read_b128 v[68:71], v27 offset:32
  ds_read_b128 v[72:75], v27 offset:64
  ds_read_b128 v[76:79], v27 offset:96
  ds_read_b128 v[80:83], v27 offset:128
  ds_read_b128 v[84:87], v27 offset:160
  ds_read_b128 v[88:91], v27 offset:192
  ds_read_b128 v[92:95], v27 offset:224
  s_mov_b64 exec, -1
  v_cvt_pk_bf16_f32 v200, v134, -v135
  v_cvt_pk_bf16_f32 v201, v162, -v163
  v_cvt_pk_bf16_f32 v202, v164, -v165
  v_cvt_pk_bf16_f32 v203, v166, -v167
  v_cvt_pk_bf16_f32 v204, v168, -v169
  v_cvt_pk_bf16_f32 v205, v170, -v171
  v_cvt_pk_bf16_f32 v206, v172, -v173
  v_cvt_pk_bf16_f32 v207, v174, -v175
  v_mul_f32 v178, v134, v132
  v_mul_f32 v179, v134, v133
  v_mul_f32 v180, v164, v132
  v_mul_f32 v181, v164, v133
  ds_write2_b32 v26, v200, v201 offset0:0 offset1:68
  v_mul_f32 v182, v168, v132
  v_mul_f32 v183, v168, v133
  v_mul_f32 v184, v172, v132
  v_mul_f32 v185, v172, v133
  ds_write2_b32 v26, v202, v203 offset0:136 offset1:204
  v_mul_f32 v186, v176, v132
  v_mul_f32 v187, v176, v133
  v_fmac_f32 v178, v135, v209
  v_fmac_f32 v179, v135, v132
  ds_write2_b32 v212, v204, v205 offset0:0 offset1:68
  v_fmac_f32 v180, v165, v209
  v_fmac_f32 v181, v165, v132
  v_fmac_f32 v182, v169, v209
  v_fmac_f32 v183, v169, v132
  ds_write2_b32 v212, v206, v207 offset0:136 offset1:204
  v_fmac_f32 v184, v173, v209
  v_fmac_f32 v185, v173, v132
  v_fmac_f32 v186, v177, v209
  v_fmac_f32 v187, v177, v132
  v_cvt_pk_bf16_f32 v200, v178, -v179
  v_cvt_pk_bf16_f32 v201, v180, -v181
  v_cvt_pk_bf16_f32 v202, v182, -v183
  v_cvt_pk_bf16_f32 v203, v184, -v185
  v_cvt_pk_bf16_f32 v204, v186, -v187
  v_mul_f32 v140, v178, v132
  v_mul_f32 v141, v178, v133
  v_mul_f32 v142, v182, v132
  ds_write2_b32 v213, v200, v201 offset0:0 offset1:68
  v_mul_f32 v143, v182, v133
  v_mul_f32 v144, v186, v132
  v_mul_f32 v145, v186, v133
  ds_write2_b32 v213, v202, v203 offset0:136 offset1:204
  v_fmac_f32 v140, v179, v209
  v_fmac_f32 v141, v179, v132
  v_fmac_f32 v142, v183, v209
  ds_write_b32 v26, v204 offset:3264
  v_fmac_f32 v143, v183, v132
  v_fmac_f32 v144, v187, v209
  v_fmac_f32 v145, v187, v132
  s_mov_b64 exec, s[72:73]
  ds_read_b128 v[96:99], v28 offset:0
  ds_read_b128 v[100:103], v28 offset:32
  ds_read_b128 v[104:107], v28 offset:64
  ds_read_b128 v[108:111], v28 offset:96
  ds_read_b128 v[112:115], v28 offset:128
  ds_read_b128 v[116:119], v28 offset:160
  ds_read_b128 v[120:123], v28 offset:192
  ds_read_b128 v[124:127], v28 offset:224
  s_mov_b64 exec, -1
  v_cvt_pk_bf16_f32 v205, v140, -v141
  v_cvt_pk_bf16_f32 v206, v142, -v143
  v_cvt_pk_bf16_f32 v207, v144, -v145
  v_mul_f32 v146, v140, v132
  v_mul_f32 v147, v140, v133
  v_mul_f32 v148, v142, v132
  v_mul_f32 v149, v142, v133
  ds_write2_b32 v26, v205, v206 offset0:0 offset1:68
  v_mul_f32 v150, v144, v132
  v_mul_f32 v151, v144, v133
  v_fmac_f32 v146, v141, v209
  v_fmac_f32 v147, v141, v132
  ds_write_b32 v26, v207 offset:544
  v_fmac_f32 v148, v143, v209
  v_fmac_f32 v149, v143, v132
  v_fmac_f32 v150, v145, v209
  v_fmac_f32 v151, v145, v132
  v_cvt_pk_bf16_f32 v200, v146, -v147
  v_cvt_pk_bf16_f32 v201, v148, -v149
  v_cvt_pk_bf16_f32 v202, v150, -v151
  v_mul_f32 v178, v146, v132
  v_mul_f32 v179, v146, v133
  v_mul_f32 v180, v150, v132
  ds_write2_b32 v212, v200, v201 offset0:0 offset1:68
  v_mul_f32 v181, v150, v133
  v_fmac_f32 v178, v147, v209
  v_fmac_f32 v179, v147, v132
  ds_write_b32 v26, v202 offset:1632
  v_fmac_f32 v180, v151, v209
  v_fmac_f32 v181, v151, v132
  v_cvt_pk_bf16_f32 v203, v178, -v179
  v_cvt_pk_bf16_f32 v204, v180, -v181
  v_mul_f32 v182, v178, v132
  v_mul_f32 v183, v178, v133
  v_mul_f32 v184, v180, v132
  v_mul_f32 v185, v180, v133
  ds_write2_b32 v213, v203, v204 offset0:0 offset1:68
  v_fmac_f32 v182, v179, v209
  v_fmac_f32 v183, v179, v132
  v_fmac_f32 v184, v181, v209
  v_fmac_f32 v185, v181, v132
  v_cvt_pk_bf16_f32 v205, v182, -v183
  v_cvt_pk_bf16_f32 v206, v184, -v185
  v_mul_f32 v178, v182, v132
  v_mul_f32 v179, v182, v133
  v_mul_f32 v180, v184, v132
  v_mul_f32 v181, v184, v133
  ds_write2_b32 v213, v205, v206 offset0:136 offset1:204
  v_fmac_f32 v178, v183, v209
  v_fmac_f32 v179, v183, v132
  v_fmac_f32 v180, v185, v209
  v_fmac_f32 v181, v185, v132
  v_cvt_pk_bf16_f32 v207, v178, -v179
  v_cvt_pk_bf16_f32 v200, v180, -v181
  v_mul_f32 v182, v178, v132
  v_mul_f32 v183, v178, v133
  v_mul_f32 v184, v180, v132
  v_mul_f32 v185, v180, v133
  ds_write2_b32 v214, v207, v200 offset0:0 offset1:68
  v_fmac_f32 v182, v179, v209
  v_fmac_f32 v183, v179, v132
  v_fmac_f32 v184, v181, v209
  v_fmac_f32 v185, v181, v132
  v_cvt_pk_bf16_f32 v201, v182, -v183
  v_cvt_pk_bf16_f32 v202, v184, -v185
  ds_write2_b32 v214, v201, v202 offset0:136 offset1:204
  s_mov_b64 exec, s[74:75]
  ds_read_b128 v[96:99], v28 offset:0
  ds_read_b128 v[100:103], v28 offset:32
  ds_read_b128 v[104:107], v28 offset:64
  ds_read_b128 v[108:111], v28 offset:96
  ds_read_b128 v[112:115], v28 offset:128
  ds_read_b128 v[116:119], v28 offset:160
  ds_read_b128 v[120:123], v28 offset:192
  ds_read_b128 v[124:127], v28 offset:224
  s_mov_b64 exec, -1
  s_waitcnt lgkmcnt(7)
  v_mfma_f32_32x32x16_bf16 v[40:55], v[96:99], v[64:67], 0
  s_waitcnt lgkmcnt(6)
  v_mfma_f32_32x32x16_bf16 v[40:55], v[100:103], v[68:71], v[40:55]
  s_waitcnt lgkmcnt(5)
  v_mfma_f32_32x32x16_bf16 v[40:55], v[104:107], v[72:75], v[40:55]
  s_waitcnt lgkmcnt(4)
  v_mfma_f32_32x32x16_bf16 v[40:55], v[108:111], v[76:79], v[40:55]
  s_waitcnt lgkmcnt(3)
  v_mfma_f32_32x32x16_bf16 v[40:55], v[112:115], v[80:83], v[40:55]
  s_waitcnt lgkmcnt(2)
  v_mfma_f32_32x32x16_bf16 v[40:55], v[116:119], v[84:87], v[40:55]
  s_waitcnt lgkmcnt(1)
  v_mfma_f32_32x32x16_bf16 v[40:55], v[120:123], v[88:91], v[40:55]
  s_waitcnt lgkmcnt(0)
  v_mfma_f32_32x32x16_bf16 v[40:55], v[124:127], v[92:95], v[40:55]
  s_mul_i32 s67, s65, -5376
  s_add_u32 s67, s67, 158720
  s_mul_i32 s68, s65, -12800
  s_add_u32 s68, s68, 161792
  v_lshl_add_u32 v26, v1, 4, s67
  v_lshl_add_u32 v27, v1, 4, s68
  s_mul_i32 s67, s65, 4544
  s_add_u32 s67, s67, 131072
  v_and_b32 v8, 31, v1
  v_lshrrev_b32 v9, 5, v1
  v_lshl_add_u32 v8, v8, 4, s67
  v_lshl_add_u32 v10, v1, 3, s67
  v_mov_b32 v12, 0
  v_mov_b32 v13, 0
  s_nop 1
  s_cmp_eq_u32 s66, 0
  s_cbranch_scc0 KX_29
  ds_write_b128 v27, v[52:55]
  s_branch KX_30
KX_29:
  ds_write_b128 v26, v[40:43] offset:0
  ds_write_b128 v26, v[44:47] offset:1024
  ds_write_b128 v26, v[48:51] offset:2048
KX_30:
  s_waitcnt lgkmcnt(0)
  v_mov_b32 v24, 1
  ds_write_b32 v22, v24
  s_cmp_eq_u32 s65, 1
  s_cbranch_scc1 S_LD
  ds_read_b32 v24, v23
  s_waitcnt lgkmcnt(0)
  v_cmp_gt_u32 vcc, 1, v24
  s_cbranch_vccz SWD_32
SW_31:
  s_sleep 1
  ds_read_b32 v24, v23
  s_waitcnt lgkmcnt(0)
  v_cmp_gt_u32 vcc, 1, v24
  s_cbranch_vccnz SW_31
SWD_32:
  s_cmp_eq_u32 s66, 0
  s_cbranch_scc0 KF_33
  ds_read_b128 v[64:67], v26 offset:0
  ds_read_b128 v[68:71], v26 offset:1024
  ds_read_b128 v[72:75], v26 offset:2048
  ds_write_b64 v10, v[12:13]
  v_cmp_eq_u32 vcc, 0, v1
  v_mov_b32 v11, s70
  v_lshl_add_u32 v14, v9, 3, v8
  v_lshl_add_u32 v15, v9, 9, v8
  v_cndmask_b32 v11, 0, v11, vcc
  v_add_f32 v40, v40, v11
  s_waitcnt lgkmcnt(1)
  v_pk_add_f32 v[40:41], v[40:41], v[64:65]
  v_pk_add_f32 v[42:43], v[42:43], v[66:67]
  v_pk_add_f32 v[44:45], v[44:45], v[68:69]
  v_pk_add_f32 v[46:47], v[46:47], v[70:71]
  v_pk_add_f32 v[48:49], v[48:49], v[72:73]
  v_pk_add_f32 v[50:51], v[50:51], v[74:75]
  v_cvt_pk_bf16_f32 v64, v40, v41
  v_cvt_pk_bf16_f32 v65, v42, v43
  v_cvt_pk_bf16_f32 v66, v44, v45
  v_cvt_pk_bf16_f32 v67, v46, v47
  v_cvt_pk_bf16_f32 v68, v48, v48
  v_cvt_pk_bf16_f32 v69, v48, v49
  v_cvt_pk_bf16_f32 v70, v49, v49
  v_cvt_pk_bf16_f32 v71, v50, v50
  ds_write_b64 v14, v[64:65] offset:448
  ds_write_b64 v14, v[66:67] offset:960
  ds_write_b128 v15, v[68:71] offset:1472
  s_branch KF_34
KF_33:
  ds_read_b128 v[64:67], v27
  s_mul_i32 s67, s65, 4160
  s_add_u32 s67, s67, 140160
  v_and_b32 v11, 15, v1
  v_lshl_add_u32 v11, v11, 2, s67
  ds_write_b32 v11, v12
  v_and_b32 v11, 1, v1
  v_cmp_eq_u32 vcc, 1, v11
  v_lshl_add_u32 v15, v9, 10, v8
  s_waitcnt lgkmcnt(1)
  v_pk_add_f32 v[52:53], v[52:53], v[64:65]
  v_pk_add_f32 v[54:55], v[54:55], v[66:67]
  v_cndmask_b32 v11, v52, v53, vcc
  v_cvt_pk_bf16_f32 v64, v52, v52
  v_cvt_pk_bf16_f32 v65, v52, v52
  v_cvt_pk_bf16_f32 v66, v11, v53
  v_cvt_pk_bf16_f32 v67, v53, v53
  ds_write_b128 v15, v[64:67] offset:2496
  v_cndmask_b32 v11, v54, v55, vcc
  v_cvt_pk_bf16_f32 v68, v54, v54
  v_cvt_pk_bf16_f32 v69, v54, v54
  v_cvt_pk_bf16_f32 v70, v11, v55
  v_cvt_pk_bf16_f32 v71, v55, v55
  ds_write_b128 v15, v[68:71] offset:3008
KF_34:
  v_mov_b32 v8, 162880
RW_35:
  ds_read_b64 v[32:33], v8
  s_waitcnt lgkmcnt(0)
  v_cmp_ne_u32 vcc, 1, v33
  s_cbranch_vccz RW_36
  s_sleep 1
  s_branch RW_35
RW_36:
  s_cmp_eq_u32 s26, 1
  s_cbranch_scc1 S_VD
  s_lshl_b32 s67, s24, 12
  s_add_u32 s67, s67, 12713984
  v_and_b32 v8, 15, v1
  v_lshl_add_u32 v8, v8, 8, s67
  s_mov_b32 s85, 100000
PU_37:
  buffer_load_dword v9, v8, s[16:19], 0 offen sc1
  s_waitcnt vmcnt(0)
  v_cmp_ne_u32 vcc, v32, v9
  s_cbranch_vccz PU_38
  s_sleep 8
  s_sub_u32 s85, s85, 1
  s_cbranch_scc0 PU_37
PU_38:
  s_lshl_b32 s67, s64, 13
  s_add_u32 s67, s67, 8388608
  s_add_u32 s68, s67, 4096
  v_lshlrev_b32 v16, 4, v1
  buffer_load_dwordx4 v[128:131], v16, s[16:19], s67 offen offset:0 sc1
  buffer_load_dwordx4 v[132:135], v16, s[16:19], s67 offen offset:1024 sc1
  buffer_load_dwordx4 v[136:139], v16, s[16:19], s67 offen offset:2048 sc1
  buffer_load_dwordx4 v[140:143], v16, s[16:19], s67 offen offset:3072 sc1
  buffer_load_dwordx4 v[144:147], v16, s[16:19], s68 offen offset:0 sc1
  buffer_load_dwordx4 v[148:151], v16, s[16:19], s68 offen offset:1024 sc1
  buffer_load_dwordx4 v[152:155], v16, s[16:19], s68 offen offset:2048 sc1
  buffer_load_dwordx4 v[156:159], v16, s[16:19], s68 offen offset:3072 sc1
  v_bfe_u32 v16, v1, 2, 1
  v_mul_u32_u24 v16, 4160, v16
  v_lshrrev_b32 v17, 3, v1
  v_lshl_add_u32 v16, v17, 6, v16
  v_and_b32 v17, 3, v1
  v_lshl_add_u32 v16, v17, 4, v16
  v_add_u32 v16, 140224, v16
  s_waitcnt vmcnt(7)
  ds_write_b128 v16, v[128:131] offset:0
  s_waitcnt vmcnt(6)
  ds_write_b128 v16, v[132:135] offset:512
  s_waitcnt vmcnt(5)
  ds_write_b128 v16, v[136:139] offset:1024
  s_waitcnt vmcnt(4)
  ds_write_b128 v16, v[140:143] offset:1536
  s_waitcnt vmcnt(3)
  ds_write_b128 v16, v[144:147] offset:2048
  s_waitcnt vmcnt(2)
  ds_write_b128 v16, v[148:151] offset:2560
  s_waitcnt vmcnt(1)
  ds_write_b128 v16, v[152:155] offset:3072
  s_waitcnt vmcnt(0)
  ds_write_b128 v16, v[156:159] offset:3584
  s_branch S_CV
S_VD:
  s_cmp_eq_u32 s2, 0
  s_cbranch_scc0 S_CV
  v_lshlrev_b32 v8, 8, v1
  v_add_u32 v8, 12648448, v8
  s_mov_b32 s85, 100000
PE_39:
  buffer_load_dword v9, v8, s[16:19], 0 offen sc1
  s_waitcnt vmcnt(0)
  v_and_b32 v10, -16, v9
  v_cmp_ne_u32 vcc, v32, v10
  s_cbranch_vccz PE_40
  s_sleep 8
  s_sub_u32 s85, s85, 1
  s_cbranch_scc0 PE_39
PE_40:
  v_lshlrev_b32 v8, 8, v1
  v_add_u32 v8, 12664832, v8
  s_mov_b32 s85, 100000
PE_41:
  buffer_load_dword v9, v8, s[16:19], 0 offen sc1
  s_waitcnt vmcnt(0)
  v_and_b32 v10, -16, v9
  v_cmp_ne_u32 vcc, v32, v10
  s_cbranch_vccz PE_42
  s_sleep 8
  s_sub_u32 s85, s85, 1
  s_cbranch_scc0 PE_41
PE_42:
  v_lshlrev_b32 v8, 8, v1
  v_add_u32 v8, 12681216, v8
  s_mov_b32 s85, 100000
PE_43:
  buffer_load_dword v9, v8, s[16:19], 0 offen sc1
  s_waitcnt vmcnt(0)
  v_and_b32 v10, -16, v9
  v_cmp_ne_u32 vcc, v32, v10
  s_cbranch_vccz PE_44
  s_sleep 8
  s_sub_u32 s85, s85, 1
  s_cbranch_scc0 PE_43
PE_44:
  v_lshlrev_b32 v8, 8, v1
  v_add_u32 v8, 12697600, v8
  s_mov_b32 s85, 100000
PE_45:
  buffer_load_dword v9, v8, s[16:19], 0 offen sc1
  s_waitcnt vmcnt(0)
  v_and_b32 v10, -16, v9
  v_cmp_ne_u32 vcc, v32, v10
  s_cbranch_vccz PE_46
  s_sleep 8
  s_sub_u32 s85, s85, 1
  s_cbranch_scc0 PE_45
PE_46:
  s_mov_b32 s67, 13565952
  v_mov_b32 v8, 0
  s_mov_b64 exec, 1
  buffer_store_dword v32, v8, s[16:19], s67 offen sc1
  s_mov_b64 exec, -1
  s_branch S_CV
S_LD:
  s_cmp_ge_u32 s25, 28
  s_cbranch_scc1 S_LW1
  ds_read_b32 v31, v63 offset:0
  s_waitcnt lgkmcnt(0)
  v_cmp_gt_u32 vcc, 1, v31
  s_cbranch_vccz LWD_48
LW_47:
  s_sleep 1
  ds_read_b32 v31, v63 offset:0
  s_waitcnt lgkmcnt(0)
  v_cmp_gt_u32 vcc, 1, v31
  s_cbranch_vccnz LW_47
LWD_48:
  s_add_u32 s82, s79, 4
  s_and_b32 s82, s82, 7
  s_lshl_b32 s83, s82, 7
  s_add_u32 s83, s83, s76
  s_mul_i32 s82, s82, 229376
  s_add_u32 s82, s82, s77
  s_add_u32 m0, s78, 0
  s_nop 0
  buffer_load_dwordx4 v16, s[4:7], s83 offen offset:0  lds
  buffer_load_dwordx4 v17, s[4:7], s83 offen offset:1024  lds
  buffer_load_dwordx4 v18, s[4:7], s83 offen offset:2048  lds
  buffer_load_dwordx4 v19, s[4:7], s83 offen offset:3072  lds
  s_add_u32 m0, s78, 16384
  s_nop 0
  buffer_load_dwordx4 v56, s[8:11], s82 offen offset:0  lds
  buffer_load_dwordx4 v57, s[8:11], s82 offen offset:1024  lds
  buffer_load_dwordx4 v58, s[8:11], s82 offen offset:2048  lds
  buffer_load_dwordx4 v59, s[8:11], s82 offen offset:3072  lds
  s_add_u32 m0, s78, 4096
  s_add_u32 s83, s83, 32768
  buffer_load_dwordx4 v16, s[4:7], s83 offen offset:0  lds
  buffer_load_dwordx4 v17, s[4:7], s83 offen offset:1024  lds
  buffer_load_dwordx4 v18, s[4:7], s83 offen offset:2048  lds
  buffer_load_dwordx4 v19, s[4:7], s83 offen offset:3072  lds
  s_add_u32 m0, s78, 20480
  s_add_u32 s82, s82, 57344
  buffer_load_dwordx4 v56, s[8:11], s82 offen offset:0  lds
  buffer_load_dwordx4 v57, s[8:11], s82 offen offset:1024  lds
  buffer_load_dwordx4 v58, s[8:11], s82 offen offset:2048  lds
  buffer_load_dwordx4 v59, s[8:11], s82 offen offset:3072  lds
  ds_read_b32 v31, v63 offset:0
  s_waitcnt lgkmcnt(0)
  v_cmp_gt_u32 vcc, 2, v31
  s_cbranch_vccz LWD_50
LW_49:
  s_sleep 1
  ds_read_b32 v31, v63 offset:0
  s_waitcnt lgkmcnt(0)
  v_cmp_gt_u32 vcc, 2, v31
  s_cbranch_vccnz LW_49
LWD_50:
  s_add_u32 s82, s79, 5
  s_and_b32 s82, s82, 7
  s_lshl_b32 s83, s82, 7
  s_add_u32 s83, s83, s76
  s_mul_i32 s82, s82, 229376
  s_add_u32 s82, s82, s77
  s_add_u32 m0, s78, 32768
  s_nop 0
  buffer_load_dwordx4 v16, s[4:7], s83 offen offset:0  lds
  buffer_load_dwordx4 v17, s[4:7], s83 offen offset:1024  lds
  buffer_load_dwordx4 v18, s[4:7], s83 offen offset:2048  lds
  buffer_load_dwordx4 v19, s[4:7], s83 offen offset:3072  lds
  s_add_u32 m0, s78, 49152
  s_nop 0
  buffer_load_dwordx4 v56, s[8:11], s82 offen offset:0  lds
  buffer_load_dwordx4 v57, s[8:11], s82 offen offset:1024  lds
  buffer_load_dwordx4 v58, s[8:11], s82 offen offset:2048  lds
  buffer_load_dwordx4 v59, s[8:11], s82 offen offset:3072  lds
  s_add_u32 m0, s78, 36864
  s_add_u32 s83, s83, 32768
  buffer_load_dwordx4 v16, s[4:7], s83 offen offset:0  lds
  buffer_load_dwordx4 v17, s[4:7], s83 offen offset:1024  lds
  buffer_load_dwordx4 v18, s[4:7], s83 offen offset:2048  lds
  buffer_load_dwordx4 v19, s[4:7], s83 offen offset:3072  lds
  s_add_u32 m0, s78, 53248
  s_add_u32 s82, s82, 57344
  buffer_load_dwordx4 v56, s[8:11], s82 offen offset:0  lds
  buffer_load_dwordx4 v57, s[8:11], s82 offen offset:1024  lds
  buffer_load_dwordx4 v58, s[8:11], s82 offen offset:2048  lds
  buffer_load_dwordx4 v59, s[8:11], s82 offen offset:3072  lds
  v_mov_b32 v20, 5
  v_mov_b32 v21, 5
  s_waitcnt vmcnt(16)
  ds_write_b64 v62, v[20:21]
  ds_read_b32 v31, v63 offset:0
  s_waitcnt lgkmcnt(0)
  v_cmp_gt_u32 vcc, 3, v31
  s_cbranch_vccz LWD_52
LW_51:
  s_sleep 1
  ds_read_b32 v31, v63 offset:0
  s_waitcnt lgkmcnt(0)
  v_cmp_gt_u32 vcc, 3, v31
  s_cbranch_vccnz LW_51
LWD_52:
  s_add_u32 s82, s79, 6
  s_and_b32 s82, s82, 7
  s_lshl_b32 s83, s82, 7
  s_add_u32 s83, s83, s76
  s_mul_i32 s82, s82, 229376
  s_add_u32 s82, s82, s77
  s_add_u32 m0, s78, 65536
  s_nop 0
  buffer_load_dwordx4 v16, s[4:7], s83 offen offset:0  lds
  buffer_load_dwordx4 v17, s[4:7], s83 offen offset:1024  lds
  buffer_load_dwordx4 v18, s[4:7], s83 offen offset:2048  lds
  buffer_load_dwordx4 v19, s[4:7], s83 offen offset:3072  lds
  s_add_u32 m0, s78, 81920
  s_nop 0
  buffer_load_dwordx4 v56, s[8:11], s82 offen offset:0  lds
  buffer_load_dwordx4 v57, s[8:11], s82 offen offset:1024  lds
  buffer_load_dwordx4 v58, s[8:11], s82 offen offset:2048  lds
  buffer_load_dwordx4 v59, s[8:11], s82 offen offset:3072  lds
  s_add_u32 m0, s78, 69632
  s_add_u32 s83, s83, 32768
  buffer_load_dwordx4 v16, s[4:7], s83 offen offset:0  lds
  buffer_load_dwordx4 v17, s[4:7], s83 offen offset:1024  lds
  buffer_load_dwordx4 v18, s[4:7], s83 offen offset:2048  lds
  buffer_load_dwordx4 v19, s[4:7], s83 offen offset:3072  lds
  s_add_u32 m0, s78, 86016
  s_add_u32 s82, s82, 57344
  buffer_load_dwordx4 v56, s[8:11], s82 offen offset:0  lds
  buffer_load_dwordx4 v57, s[8:11], s82 offen offset:1024  lds
  buffer_load_dwordx4 v58, s[8:11], s82 offen offset:2048  lds
  buffer_load_dwordx4 v59, s[8:11], s82 offen offset:3072  lds
  v_mov_b32 v20, 6
  v_mov_b32 v21, 6
  s_waitcnt vmcnt(16)
  ds_write_b64 v62, v[20:21]
  ds_read_b32 v31, v63 offset:0
  s_waitcnt lgkmcnt(0)
  v_cmp_gt_u32 vcc, 4, v31
  s_cbranch_vccz LWD_54
LW_53:
  s_sleep 1
  ds_read_b32 v31, v63 offset:0
  s_waitcnt lgkmcnt(0)
  v_cmp_gt_u32 vcc, 4, v31
  s_cbranch_vccnz LW_53
LWD_54:
  s_add_u32 s82, s79, 7
  s_and_b32 s82, s82, 7
  s_lshl_b32 s83, s82, 7
  s_add_u32 s83, s83, s76
  s_mul_i32 s82, s82, 229376
  s_add_u32 s82, s82, s77
  s_add_u32 m0, s78, 98304
  s_nop 0
  buffer_load_dwordx4 v16, s[4:7], s83 offen offset:0  lds
  buffer_load_dwordx4 v17, s[4:7], s83 offen offset:1024  lds
  buffer_load_dwordx4 v18, s[4:7], s83 offen offset:2048  lds
  buffer_load_dwordx4 v19, s[4:7], s83 offen offset:3072  lds
  s_add_u32 m0, s78, 114688
  s_nop 0
  buffer_load_dwordx4 v56, s[8:11], s82 offen offset:0  lds
  buffer_load_dwordx4 v57, s[8:11], s82 offen offset:1024  lds
  buffer_load_dwordx4 v58, s[8:11], s82 offen offset:2048  lds
  buffer_load_dwordx4 v59, s[8:11], s82 offen offset:3072  lds
  s_add_u32 m0, s78, 102400
  s_add_u32 s83, s83, 32768
  buffer_load_dwordx4 v16, s[4:7], s83 offen offset:0  lds
  buffer_load_dwordx4 v17, s[4:7], s83 offen offset:1024  lds
  buffer_load_dwordx4 v18, s[4:7], s83 offen offset:2048  lds
  buffer_load_dwordx4 v19, s[4:7], s83 offen offset:3072  lds
  s_add_u32 m0, s78, 118784
  s_add_u32 s82, s82, 57344
  buffer_load_dwordx4 v56, s[8:11], s82 offen offset:0  lds
  buffer_load_dwordx4 v57, s[8:11], s82 offen offset:1024  lds
  buffer_load_dwordx4 v58, s[8:11], s82 offen offset:2048  lds
  buffer_load_dwordx4 v59, s[8:11], s82 offen offset:3072  lds
  v_mov_b32 v20, 7
  v_mov_b32 v21, 7
  s_waitcnt vmcnt(16)
  ds_write_b64 v62, v[20:21]
S_LW1:
  ds_read_b32 v24, v23
  s_waitcnt lgkmcnt(0)
  v_cmp_gt_u32 vcc, 1, v24
  s_cbranch_vccz SWD_56
SW_55:
  s_sleep 1
  ds_read_b32 v24, v23
  s_waitcnt lgkmcnt(0)
  v_cmp_gt_u32 vcc, 1, v24
  s_cbranch_vccnz SW_55
SWD_56:
  s_cmp_eq_u32 s66, 0
  s_cbranch_scc0 KF_57
  ds_read_b128 v[64:67], v26 offset:0
  ds_read_b128 v[68:71], v26 offset:1024
  ds_read_b128 v[72:75], v26 offset:2048
  ds_write_b64 v10, v[12:13]
  v_cmp_eq_u32 vcc, 0, v1
  v_mov_b32 v11, s70
  v_lshl_add_u32 v14, v9, 3, v8
  v_lshl_add_u32 v15, v9, 9, v8
  v_cndmask_b32 v11, 0, v11, vcc
  v_add_f32 v40, v40, v11
  s_waitcnt lgkmcnt(1)
  v_pk_add_f32 v[40:41], v[40:41], v[64:65]
  v_pk_add_f32 v[42:43], v[42:43], v[66:67]
  v_pk_add_f32 v[44:45], v[44:45], v[68:69]
  v_pk_add_f32 v[46:47], v[46:47], v[70:71]
  v_pk_add_f32 v[48:49], v[48:49], v[72:73]
  v_pk_add_f32 v[50:51], v[50:51], v[74:75]
  v_cvt_pk_bf16_f32 v64, v40, v41
  v_cvt_pk_bf16_f32 v65, v42, v43
  v_cvt_pk_bf16_f32 v66, v44, v45
  v_cvt_pk_bf16_f32 v67, v46, v47
  v_cvt_pk_bf16_f32 v68, v48, v48
  v_cvt_pk_bf16_f32 v69, v48, v49
  v_cvt_pk_bf16_f32 v70, v49, v49
  v_cvt_pk_bf16_f32 v71, v50, v50
  ds_write_b64 v14, v[64:65] offset:448
  ds_write_b64 v14, v[66:67] offset:960
  ds_write_b128 v15, v[68:71] offset:1472
  s_branch KF_58
KF_57:
  ds_read_b128 v[64:67], v27
  s_mul_i32 s67, s65, 4160
  s_add_u32 s67, s67, 140160
  v_and_b32 v11, 15, v1
  v_lshl_add_u32 v11, v11, 2, s67
  ds_write_b32 v11, v12
  v_and_b32 v11, 1, v1
  v_cmp_eq_u32 vcc, 1, v11
  v_lshl_add_u32 v15, v9, 10, v8
  s_waitcnt lgkmcnt(1)
  v_pk_add_f32 v[52:53], v[52:53], v[64:65]
  v_pk_add_f32 v[54:55], v[54:55], v[66:67]
  v_cndmask_b32 v11, v52, v53, vcc
  v_cvt_pk_bf16_f32 v64, v52, v52
  v_cvt_pk_bf16_f32 v65, v52, v52
  v_cvt_pk_bf16_f32 v66, v11, v53
  v_cvt_pk_bf16_f32 v67, v53, v53
  ds_write_b128 v15, v[64:67] offset:2496
  v_cndmask_b32 v11, v54, v55, vcc
  v_cvt_pk_bf16_f32 v68, v54, v54
  v_cvt_pk_bf16_f32 v69, v54, v54
  v_cvt_pk_bf16_f32 v70, v11, v55
  v_cvt_pk_bf16_f32 v71, v55, v55
  ds_write_b128 v15, v[68:71] offset:3008
KF_58:
  v_mov_b32 v8, 162880
RW_59:
  ds_read_b64 v[32:33], v8
  s_waitcnt lgkmcnt(0)
  v_cmp_ne_u32 vcc, 1, v33
  s_cbranch_vccz RW_60
  s_sleep 1
  s_branch RW_59
RW_60:
  s_cmp_ge_u32 s25, 28
  s_cbranch_scc1 S_LW2
S_LW2:
  ds_read_b32 v31, v63 offset:0
  s_waitcnt lgkmcnt(0)
  v_cmp_gt_u32 vcc, 5, v31
  s_cbranch_vccz LWD_62
LW_61:
  s_sleep 1
  ds_read_b32 v31, v63 offset:0
  s_waitcnt lgkmcnt(0)
  v_cmp_gt_u32 vcc, 5, v31
  s_cbranch_vccnz LW_61
LWD_62:
  s_add_u32 m0, s81, 4096
  s_add_u32 s82, s80, 0
  buffer_load_dwordx4 v60, s[12:15], s82 offen  lds
  buffer_load_dwordx4 v61, s[12:15], s82 offen offset:1024  lds
  s_add_u32 m0, s81, 6144
  s_add_u32 s82, s80, 16384
  buffer_load_dwordx4 v60, s[12:15], s82 offen  lds
  buffer_load_dwordx4 v61, s[12:15], s82 offen offset:1024  lds
  s_add_u32 m0, s81, 8192
  s_add_u32 s82, s80, 32768
  buffer_load_dwordx4 v60, s[12:15], s82 offen  lds
  buffer_load_dwordx4 v61, s[12:15], s82 offen offset:1024  lds
  s_add_u32 m0, s81, 10240
  s_add_u32 s82, s80, 49152
  buffer_load_dwordx4 v60, s[12:15], s82 offen  lds
  buffer_load_dwordx4 v61, s[12:15], s82 offen offset:1024  lds
  s_add_u32 m0, s81, 12288
  s_add_u32 s82, s80, 65536
  buffer_load_dwordx4 v60, s[12:15], s82 offen  lds
  buffer_load_dwordx4 v61, s[12:15], s82 offen offset:1024  lds
  s_add_u32 m0, s81, 14336
  s_add_u32 s82, s80, 81920
  buffer_load_dwordx4 v60, s[12:15], s82 offen  lds
  buffer_load_dwordx4 v61, s[12:15], s82 offen offset:1024  lds
  s_add_u32 m0, s81, 16384
  s_add_u32 s82, s80, 98304
  buffer_load_dwordx4 v60, s[12:15], s82 offen  lds
  buffer_load_dwordx4 v61, s[12:15], s82 offen offset:1024  lds
  v_mov_b32 v20, 8
  v_mov_b32 v21, 8
  s_waitcnt vmcnt(14)
  ds_write_b64 v62, v[20:21]
  ds_read_b32 v31, v63 offset:0
  s_waitcnt lgkmcnt(0)
  v_cmp_gt_u32 vcc, 6, v31
  s_cbranch_vccz LWD_64
LW_63:
  s_sleep 1
  ds_read_b32 v31, v63 offset:0
  s_waitcnt lgkmcnt(0)
  v_cmp_gt_u32 vcc, 6, v31
  s_cbranch_vccnz LW_63
LWD_64:
  s_add_u32 m0, s81, 36864
  s_add_u32 s82, s80, 458752
  buffer_load_dwordx4 v60, s[12:15], s82 offen  lds
  buffer_load_dwordx4 v61, s[12:15], s82 offen offset:1024  lds
  s_add_u32 m0, s81, 38912
  s_add_u32 s82, s80, 475136
  buffer_load_dwordx4 v60, s[12:15], s82 offen  lds
  buffer_load_dwordx4 v61, s[12:15], s82 offen offset:1024  lds
  s_add_u32 m0, s81, 40960
  s_add_u32 s82, s80, 491520
  buffer_load_dwordx4 v60, s[12:15], s82 offen  lds
  buffer_load_dwordx4 v61, s[12:15], s82 offen offset:1024  lds
  s_add_u32 m0, s81, 43008
  s_add_u32 s82, s80, 507904
  buffer_load_dwordx4 v60, s[12:15], s82 offen  lds
  buffer_load_dwordx4 v61, s[12:15], s82 offen offset:1024  lds
  s_add_u32 m0, s81, 45056
  s_add_u32 s82, s80, 524288
  buffer_load_dwordx4 v60, s[12:15], s82 offen  lds
  buffer_load_dwordx4 v61, s[12:15], s82 offen offset:1024  lds
  s_add_u32 m0, s81, 47104
  s_add_u32 s82, s80, 540672
  buffer_load_dwordx4 v60, s[12:15], s82 offen  lds
  buffer_load_dwordx4 v61, s[12:15], s82 offen offset:1024  lds
  s_add_u32 m0, s81, 49152
  s_add_u32 s82, s80, 557056
  buffer_load_dwordx4 v60, s[12:15], s82 offen  lds
  buffer_load_dwordx4 v61, s[12:15], s82 offen offset:1024  lds
  ds_read_b32 v31, v63 offset:0
  s_waitcnt lgkmcnt(0)
  v_cmp_gt_u32 vcc, 7, v31
  s_cbranch_vccz LWD_66
LW_65:
  s_sleep 1
  ds_read_b32 v31, v63 offset:0
  s_waitcnt lgkmcnt(0)
  v_cmp_gt_u32 vcc, 7, v31
  s_cbranch_vccnz LW_65
LWD_66:
  s_add_u32 m0, s81, 69632
  s_add_u32 s82, s80, 917504
  buffer_load_dwordx4 v60, s[12:15], s82 offen  lds
  buffer_load_dwordx4 v61, s[12:15], s82 offen offset:1024  lds
  s_add_u32 m0, s81, 71680
  s_add_u32 s82, s80, 933888
  buffer_load_dwordx4 v60, s[12:15], s82 offen  lds
  buffer_load_dwordx4 v61, s[12:15], s82 offen offset:1024  lds
  s_add_u32 m0, s81, 73728
  s_add_u32 s82, s80, 950272
  buffer_load_dwordx4 v60, s[12:15], s82 offen  lds
  buffer_load_dwordx4 v61, s[12:15], s82 offen offset:1024  lds
  s_add_u32 m0, s81, 75776
  s_add_u32 s82, s80, 966656
  buffer_load_dwordx4 v60, s[12:15], s82 offen  lds
  buffer_load_dwordx4 v61, s[12:15], s82 offen offset:1024  lds
  s_add_u32 m0, s81, 77824
  s_add_u32 s82, s80, 983040
  buffer_load_dwordx4 v60, s[12:15], s82 offen  lds
  buffer_load_dwordx4 v61, s[12:15], s82 offen offset:1024  lds
  s_add_u32 m0, s81, 79872
  s_add_u32 s82, s80, 999424
  buffer_load_dwordx4 v60, s[12:15], s82 offen  lds
  buffer_load_dwordx4 v61, s[12:15], s82 offen offset:1024  lds
  s_add_u32 m0, s81, 81920
  s_add_u32 s82, s80, 1015808
  buffer_load_dwordx4 v60, s[12:15], s82 offen  lds
  buffer_load_dwordx4 v61, s[12:15], s82 offen offset:1024  lds
  ds_read_b32 v31, v63 offset:0
  s_waitcnt lgkmcnt(0)
  v_cmp_gt_u32 vcc, 8, v31
  s_cbranch_vccz LWD_68
LW_67:
  s_sleep 1
  ds_read_b32 v31, v63 offset:0
  s_waitcnt lgkmcnt(0)
  v_cmp_gt_u32 vcc, 8, v31
  s_cbranch_vccnz LW_67
LWD_68:
  s_add_u32 m0, s81, 102400
  s_add_u32 s82, s80, 1376256
  buffer_load_dwordx4 v60, s[12:15], s82 offen  lds
  buffer_load_dwordx4 v61, s[12:15], s82 offen offset:1024  lds
  s_add_u32 m0, s81, 104448
  s_add_u32 s82, s80, 1392640
  buffer_load_dwordx4 v60, s[12:15], s82 offen  lds
  buffer_load_dwordx4 v61, s[12:15], s82 offen offset:1024  lds
  s_add_u32 m0, s81, 106496
  s_add_u32 s82, s80, 1409024
  buffer_load_dwordx4 v60, s[12:15], s82 offen  lds
  buffer_load_dwordx4 v61, s[12:15], s82 offen offset:1024  lds
  s_add_u32 m0, s81, 108544
  s_add_u32 s82, s80, 1425408
  buffer_load_dwordx4 v60, s[12:15], s82 offen  lds
  buffer_load_dwordx4 v61, s[12:15], s82 offen offset:1024  lds
  s_add_u32 m0, s81, 110592
  s_add_u32 s82, s80, 1441792
  buffer_load_dwordx4 v60, s[12:15], s82 offen  lds
  buffer_load_dwordx4 v61, s[12:15], s82 offen offset:1024  lds
  s_add_u32 m0, s81, 112640
  s_add_u32 s82, s80, 1458176
  buffer_load_dwordx4 v60, s[12:15], s82 offen  lds
  buffer_load_dwordx4 v61, s[12:15], s82 offen offset:1024  lds
  s_add_u32 m0, s81, 114688
  s_add_u32 s82, s80, 1474560
  buffer_load_dwordx4 v60, s[12:15], s82 offen  lds
  buffer_load_dwordx4 v61, s[12:15], s82 offen offset:1024  lds
S_CV:
  v_lshrrev_b32 v8, 5, v1
  v_bfe_u32 v9, v1, 2, 2
  v_bfe_u32 v10, v1, 4, 1
  v_and_b32 v11, 3, v1
  v_lshl_add_u32 v12, v10, 2, v11
  v_sub_u32 v12, v12, v8
  v_lshlrev_b32 v12, 3, v12
  v_sub_u32 v12, v12, v9
  s_mul_i32 s67, s65, 4544
  s_add_u32 s67, s67, 131160
  v_lshl_add_u32 v26, v12, 3, s67
  v_lshl_add_u32 v12, v8, 1, v10
  v_lshl_add_u32 v12, v12, 2, v9
  v_add_u32 v12, v12, v11
  s_mul_i32 s67, s65, 4160
  s_add_u32 s67, s67, 140168
  v_lshl_add_u32 v27, v12, 3, s67
  s_lshl_b32 s67, s65, 1
  s_add_u32 s67, s67, 148480
  v_lshl_add_u32 v28, v1, 2, s67
  v_lshlrev_b32 v12, 2, v1
  v_add_u32 v13, 158304, v12
  s_lshl_b32 s67, s65, 7
  s_add_u32 s67, s67, 157760
  v_add_u32 v12, s67, v12
  v_cmp_gt_u32 vcc, 4, v1
  s_mul_i32 s67, s65, 144
  s_add_u32 s67, s67, 158016
  v_cndmask_b32 v29, v13, v12, vcc
  v_cmp_eq_u32 vcc, 63, v1
  v_mov_b32 v12, s67
  s_nop 0
  v_cndmask_b32 v30, v13, v12, vcc
  v_mov_b32 v20, 12
  v_mov_b32 v21, 12
  s_waitcnt lgkmcnt(0)
  v_mov_b32 v24, 2
  ds_write_b32 v22, v24
  ds_read_b32 v24, v23
  s_waitcnt lgkmcnt(0)
  v_cmp_gt_u32 vcc, 2, v24
  s_cbranch_vccz SWD_70
SW_69:
  s_sleep 1
  ds_read_b32 v24, v23
  s_waitcnt lgkmcnt(0)
  v_cmp_gt_u32 vcc, 2, v24
  s_cbranch_vccnz SW_69
SWD_70:
  s_setprio 1
  s_cmp_eq_u32 s66, 0
  s_cbranch_scc0 CV_71
  ds_read_b64_tr_b16 v[40:41], v27 offset:0
  ds_read_b64_tr_b16 v[42:43], v27 offset:32
  ds_read_b64_tr_b16 v[140:141], v26 offset:416
  ds_read_b64_tr_b16 v[142:143], v26 offset:384
  ds_read_b64_tr_b16 v[188:189], v26 offset:1952
  ds_read_b64_tr_b16 v[190:191], v26 offset:1920
  ds_read_b64_tr_b16 v[204:205], v26 offset:2464
  ds_read_b64_tr_b16 v[206:207], v26 offset:2432
  ds_read_b64_tr_b16 v[252:253], v26 offset:4000
  ds_read_b64_tr_b16 v[254:255], v26 offset:3968
  ds_read_b64_tr_b16 v[44:45], v27 offset:128
  ds_read_b64_tr_b16 v[46:47], v27 offset:160
  ds_read_b64_tr_b16 v[136:137], v26 offset:288
  ds_read_b64_tr_b16 v[138:139], v26 offset:256
  s_waitcnt lgkmcnt(10)
  v_mfma_f32_32x32x16_bf16 v[64:79], v[140:143], v[40:43], 0
  ds_read_b64_tr_b16 v[184:185], v26 offset:1824
  ds_read_b64_tr_b16 v[186:187], v26 offset:1792
  ds_read_b64_tr_b16 v[200:201], v26 offset:2336
  ds_read_b64_tr_b16 v[202:203], v26 offset:2304
  s_waitcnt lgkmcnt(12)
  v_mfma_f32_32x32x16_bf16 v[80:95], v[188:191], v[40:43], 0
  ds_read_b64_tr_b16 v[248:249], v26 offset:3872
  ds_read_b64_tr_b16 v[250:251], v26 offset:3840
  s_waitcnt lgkmcnt(12)
  v_mfma_f32_32x32x16_bf16 v[96:111], v[204:207], v[40:43], 0
  ds_read_b64_tr_b16 v[48:49], v27 offset:256
  ds_read_b64_tr_b16 v[50:51], v27 offset:288
  s_waitcnt lgkmcnt(12)
  v_mfma_f32_32x32x16_bf16 v[112:127], v[252:255], v[40:43], 0
  ds_read_b64_tr_b16 v[132:133], v26 offset:160
  ds_read_b64_tr_b16 v[134:135], v26 offset:128
  s_waitcnt lgkmcnt(10)
  v_mfma_f32_32x32x16_bf16 v[64:79], v[136:139], v[44:47], v[64:79]
  ds_read_b64_tr_b16 v[180:181], v26 offset:1696
  ds_read_b64_tr_b16 v[182:183], v26 offset:1664
  ds_read_b64_tr_b16 v[196:197], v26 offset:2208
  ds_read_b64_tr_b16 v[198:199], v26 offset:2176
  s_waitcnt lgkmcnt(12)
  v_mfma_f32_32x32x16_bf16 v[80:95], v[184:187], v[44:47], v[80:95]
  ds_read_b64_tr_b16 v[244:245], v26 offset:3744
  ds_read_b64_tr_b16 v[246:247], v26 offset:3712
  s_waitcnt lgkmcnt(12)
  v_mfma_f32_32x32x16_bf16 v[96:111], v[200:203], v[44:47], v[96:111]
  ds_read_b64_tr_b16 v[52:53], v27 offset:384
  ds_read_b64_tr_b16 v[54:55], v27 offset:416
  s_waitcnt lgkmcnt(12)
  v_mfma_f32_32x32x16_bf16 v[112:127], v[248:251], v[44:47], v[112:127]
  ds_read_b64_tr_b16 v[128:129], v26 offset:32
  ds_read_b64_tr_b16 v[130:131], v26 offset:0
  s_waitcnt lgkmcnt(10)
  v_mfma_f32_32x32x16_bf16 v[64:79], v[132:135], v[48:51], v[64:79]
  ds_read_b64_tr_b16 v[176:177], v26 offset:1568
  ds_read_b64_tr_b16 v[178:179], v26 offset:1536
  ds_read_b64_tr_b16 v[192:193], v26 offset:2080
  ds_read_b64_tr_b16 v[194:195], v26 offset:2048
  s_waitcnt lgkmcnt(12)
  v_mfma_f32_32x32x16_bf16 v[80:95], v[180:183], v[48:51], v[80:95]
  ds_read_b64_tr_b16 v[240:241], v26 offset:3616
  ds_read_b64_tr_b16 v[242:243], v26 offset:3584
  s_waitcnt lgkmcnt(12)
  v_mfma_f32_32x32x16_bf16 v[96:111], v[196:199], v[48:51], v[96:111]
  ds_read_b64_tr_b16 v[40:41], v27 offset:512
  ds_read_b64_tr_b16 v[42:43], v27 offset:544
  s_waitcnt lgkmcnt(12)
  v_mfma_f32_32x32x16_bf16 v[112:127], v[244:247], v[48:51], v[112:127]
  ds_read_b64_tr_b16 v[172:173], v26 offset:1440
  ds_read_b64_tr_b16 v[174:175], v26 offset:1408
  s_waitcnt lgkmcnt(10)
  v_mfma_f32_32x32x16_bf16 v[64:79], v[128:131], v[52:55], v[64:79]
  s_waitcnt vmcnt(0)
  ds_write_b64 v62, v[20:21]
  ds_read_b64_tr_b16 v[236:237], v26 offset:3488
  ds_read_b64_tr_b16 v[238:239], v26 offset:3456
  s_waitcnt lgkmcnt(11)
  v_mfma_f32_32x32x16_bf16 v[80:95], v[176:179], v[52:55], v[80:95]
  ds_read_b64_tr_b16 v[44:45], v27 offset:640
  ds_read_b64_tr_b16 v[46:47], v27 offset:672
  s_waitcnt lgkmcnt(11)
  v_mfma_f32_32x32x16_bf16 v[96:111], v[192:195], v[52:55], v[96:111]
  v_add_f32_dpp v2, v67, v66 wave_shr:1 row_mask:0xf bank_mask:0xf bound_ctrl:1
  v_add_f32_dpp v3, v67, v70 wave_ror:1 row_mask:0xf bank_mask:0xf
  v_add_f32_dpp v3, v71, v70 wave_shr:1 row_mask:0xf bank_mask:0xf
  v_add_f32_dpp v4, v71, v74 wave_ror:1 row_mask:0xf bank_mask:0xf
  v_add_f32_dpp v4, v75, v74 wave_shr:1 row_mask:0xf bank_mask:0xf
  ds_read_b64_tr_b16 v[168:169], v26 offset:1312
  ds_read_b64_tr_b16 v[170:171], v26 offset:1280
  s_waitcnt lgkmcnt(11)
  v_mfma_f32_32x32x16_bf16 v[112:127], v[240:243], v[52:55], v[112:127]
  v_add_f32_dpp v5, v75, v78 wave_ror:1 row_mask:0xf bank_mask:0xf
  v_add_f32_dpp v5, v79, v78 wave_shr:1 row_mask:0xf bank_mask:0xf
  v_add_f32_dpp v6, v2, v65 wave_shr:1 row_mask:0xf bank_mask:0xf bound_ctrl:1
  v_add_f32_dpp v7, v2, v69 wave_ror:1 row_mask:0xf bank_mask:0xf
  v_add_f32_dpp v7, v3, v69 wave_shr:1 row_mask:0xf bank_mask:0xf
  ds_read_b64_tr_b16 v[232:233], v26 offset:3360
  ds_read_b64_tr_b16 v[234:235], v26 offset:3328
  s_waitcnt lgkmcnt(9)
  v_mfma_f32_32x32x16_bf16 v[80:95], v[172:175], v[40:43], v[80:95]
  v_add_f32_dpp v8, v3, v73 wave_ror:1 row_mask:0xf bank_mask:0xf
  v_add_f32_dpp v8, v4, v73 wave_shr:1 row_mask:0xf bank_mask:0xf
  v_add_f32_dpp v9, v4, v77 wave_ror:1 row_mask:0xf bank_mask:0xf
  v_add_f32_dpp v9, v5, v77 wave_shr:1 row_mask:0xf bank_mask:0xf
  v_add_f32_dpp v10, v6, v64 wave_shr:1 row_mask:0xf bank_mask:0xf bound_ctrl:1
  ds_read_b64_tr_b16 v[48:49], v27 offset:768
  ds_read_b64_tr_b16 v[50:51], v27 offset:800
  ds_read_b64_tr_b16 v[164:165], v26 offset:1184
  ds_read_b64_tr_b16 v[166:167], v26 offset:1152
  v_mfma_f32_32x32x16_bf16 v[96:111], v[188:191], v[40:43], v[96:111]
  v_add_f32_dpp v11, v6, v68 wave_ror:1 row_mask:0xf bank_mask:0xf
  v_add_f32_dpp v11, v7, v68 wave_shr:1 row_mask:0xf bank_mask:0xf
  v_add_f32_dpp v12, v7, v72 wave_ror:1 row_mask:0xf bank_mask:0xf
  v_add_f32_dpp v12, v8, v72 wave_shr:1 row_mask:0xf bank_mask:0xf
  v_add_f32_dpp v13, v8, v76 wave_ror:1 row_mask:0xf bank_mask:0xf
  s_waitcnt lgkmcnt(10)
  v_mfma_f32_32x32x16_bf16 v[112:127], v[236:239], v[40:43], v[112:127]
  v_add_f32_dpp v13, v9, v76 wave_shr:1 row_mask:0xf bank_mask:0xf
  v_cvt_pk_bf16_f32 v14, v10, v11
  v_cvt_pk_bf16_f32 v15, v12, v13
  ds_write_b32 v29, v10 offset:0
  ds_write_b32 v30, v9 offset:16
  ds_read_b64_tr_b16 v[228:229], v26 offset:3232
  ds_read_b64_tr_b16 v[230:231], v26 offset:3200
  s_waitcnt lgkmcnt(10)
  v_mfma_f32_32x32x16_bf16 v[80:95], v[168:171], v[44:47], v[80:95]
  ds_write_b32 v30, v5 offset:20
  ds_write_b32 v30, v79 offset:24
  ds_write_b16 v28, v14 offset:0
  ds_write_b16_d16_hi v28, v14 offset:256
  ds_write_b16 v28, v15 offset:512
  v_mfma_f32_32x32x16_bf16 v[96:111], v[184:187], v[44:47], v[96:111]
  ds_write_b16_d16_hi v28, v15 offset:768
  s_waitcnt lgkmcnt(14)
  v_mfma_f32_32x32x16_bf16 v[112:127], v[232:235], v[44:47], v[112:127]
  s_waitcnt lgkmcnt(10)
  v_mfma_f32_32x32x16_bf16 v[80:95], v[164:167], v[48:51], v[80:95]
  ds_read_b64_tr_b16 v[52:53], v27 offset:896
  ds_read_b64_tr_b16 v[54:55], v27 offset:928
  ds_read_b64_tr_b16 v[160:161], v26 offset:1056
  ds_read_b64_tr_b16 v[162:163], v26 offset:1024
  v_mfma_f32_32x32x16_bf16 v[96:111], v[180:183], v[48:51], v[96:111]
  s_waitcnt lgkmcnt(10)
  v_mfma_f32_32x32x16_bf16 v[112:127], v[228:231], v[48:51], v[112:127]
  ds_read_b64_tr_b16 v[224:225], v26 offset:3104
  ds_read_b64_tr_b16 v[226:227], v26 offset:3072
  ds_read_b64_tr_b16 v[40:41], v27 offset:1024
  ds_read_b64_tr_b16 v[42:43], v27 offset:1056
  s_waitcnt lgkmcnt(4)
  v_mfma_f32_32x32x16_bf16 v[80:95], v[160:163], v[52:55], v[80:95]
  ds_read_b64_tr_b16 v[156:157], v26 offset:928
  ds_read_b64_tr_b16 v[158:159], v26 offset:896
  ds_read_b64_tr_b16 v[220:221], v26 offset:2976
  ds_read_b64_tr_b16 v[222:223], v26 offset:2944
  ds_read_b64_tr_b16 v[44:45], v27 offset:1152
  ds_read_b64_tr_b16 v[46:47], v27 offset:1184
  ds_read_b64_tr_b16 v[152:153], v26 offset:800
  ds_read_b64_tr_b16 v[154:155], v26 offset:768
  v_mfma_f32_32x32x16_bf16 v[96:111], v[176:179], v[52:55], v[96:111]
  s_waitcnt lgkmcnt(10)
  v_mfma_f32_32x32x16_bf16 v[112:127], v[224:227], v[52:55], v[112:127]
  ds_read_b64_tr_b16 v[216:217], v26 offset:2848
  ds_read_b64_tr_b16 v[218:219], v26 offset:2816
  s_waitcnt lgkmcnt(8)
  v_mfma_f32_32x32x16_bf16 v[80:95], v[156:159], v[40:43], v[80:95]
  ds_read_b64_tr_b16 v[48:49], v27 offset:1280
  ds_read_b64_tr_b16 v[50:51], v27 offset:1312
  ds_read_b64_tr_b16 v[148:149], v26 offset:672
  ds_read_b64_tr_b16 v[150:151], v26 offset:640
  v_mfma_f32_32x32x16_bf16 v[96:111], v[172:175], v[40:43], v[96:111]
  s_waitcnt lgkmcnt(10)
  v_mfma_f32_32x32x16_bf16 v[112:127], v[220:223], v[40:43], v[112:127]
  ds_read_b64_tr_b16 v[212:213], v26 offset:2720
  ds_read_b64_tr_b16 v[214:215], v26 offset:2688
  s_waitcnt lgkmcnt(8)
  v_mfma_f32_32x32x16_bf16 v[80:95], v[152:155], v[44:47], v[80:95]
  ds_read_b64_tr_b16 v[52:53], v27 offset:1408
  ds_read_b64_tr_b16 v[54:55], v27 offset:1440
  ds_read_b64_tr_b16 v[144:145], v26 offset:544
  ds_read_b64_tr_b16 v[146:147], v26 offset:512
  v_mfma_f32_32x32x16_bf16 v[96:111], v[168:171], v[44:47], v[96:111]
  s_waitcnt lgkmcnt(10)
  v_mfma_f32_32x32x16_bf16 v[112:127], v[216:219], v[44:47], v[112:127]
  ds_read_b64_tr_b16 v[208:209], v26 offset:2592
  ds_read_b64_tr_b16 v[210:211], v26 offset:2560
  s_waitcnt lgkmcnt(8)
  v_mfma_f32_32x32x16_bf16 v[80:95], v[148:151], v[48:51], v[80:95]
  ds_read_b64_tr_b16 v[40:41], v27 offset:1536
  ds_read_b64_tr_b16 v[42:43], v27 offset:1568
  v_mfma_f32_32x32x16_bf16 v[96:111], v[164:167], v[48:51], v[96:111]
  s_waitcnt lgkmcnt(8)
  v_mfma_f32_32x32x16_bf16 v[112:127], v[212:215], v[48:51], v[112:127]
  s_waitcnt lgkmcnt(4)
  v_mfma_f32_32x32x16_bf16 v[80:95], v[144:147], v[52:55], v[80:95]
  ds_read_b64_tr_b16 v[44:45], v27 offset:1664
  ds_read_b64_tr_b16 v[46:47], v27 offset:1696
  v_mfma_f32_32x32x16_bf16 v[96:111], v[160:163], v[52:55], v[96:111]
  s_waitcnt lgkmcnt(4)
  v_mfma_f32_32x32x16_bf16 v[112:127], v[208:211], v[52:55], v[112:127]
  s_waitcnt lgkmcnt(2)
  v_mfma_f32_32x32x16_bf16 v[80:95], v[140:143], v[40:43], v[80:95]
  ds_read_b64_tr_b16 v[48:49], v27 offset:1792
  ds_read_b64_tr_b16 v[50:51], v27 offset:1824
  v_mfma_f32_32x32x16_bf16 v[96:111], v[156:159], v[40:43], v[96:111]
  v_mfma_f32_32x32x16_bf16 v[112:127], v[204:207], v[40:43], v[112:127]
  s_waitcnt lgkmcnt(2)
  v_mfma_f32_32x32x16_bf16 v[80:95], v[136:139], v[44:47], v[80:95]
  ds_read_b64_tr_b16 v[52:53], v27 offset:1920
  ds_read_b64_tr_b16 v[54:55], v27 offset:1952
  v_mfma_f32_32x32x16_bf16 v[96:111], v[152:155], v[44:47], v[96:111]
  v_mfma_f32_32x32x16_bf16 v[112:127], v[200:203], v[44:47], v[112:127]
  s_waitcnt lgkmcnt(2)
  v_mfma_f32_32x32x16_bf16 v[80:95], v[132:135], v[48:51], v[80:95]
  ds_read_b64_tr_b16 v[40:41], v27 offset:2048
  ds_read_b64_tr_b16 v[42:43], v27 offset:2080
  v_mfma_f32_32x32x16_bf16 v[96:111], v[148:151], v[48:51], v[96:111]
  v_mfma_f32_32x32x16_bf16 v[112:127], v[196:199], v[48:51], v[112:127]
  ds_read_b64_tr_b16 v[44:45], v27 offset:2176
  ds_read_b64_tr_b16 v[46:47], v27 offset:2208
  s_waitcnt lgkmcnt(4)
  v_mfma_f32_32x32x16_bf16 v[80:95], v[128:131], v[52:55], v[80:95]
  v_mfma_f32_32x32x16_bf16 v[96:111], v[144:147], v[52:55], v[96:111]
  ds_read_b64_tr_b16 v[48:49], v27 offset:2304
  ds_read_b64_tr_b16 v[50:51], v27 offset:2336
  v_mfma_f32_32x32x16_bf16 v[112:127], v[192:195], v[52:55], v[112:127]
  v_add_f32_dpp v2, v83, v82 wave_shr:1 row_mask:0xf bank_mask:0xf bound_ctrl:1
  v_add_f32_dpp v3, v83, v86 wave_ror:1 row_mask:0xf bank_mask:0xf
  v_add_f32_dpp v3, v87, v86 wave_shr:1 row_mask:0xf bank_mask:0xf
  v_add_f32_dpp v4, v87, v90 wave_ror:1 row_mask:0xf bank_mask:0xf
  v_add_f32_dpp v4, v91, v90 wave_shr:1 row_mask:0xf bank_mask:0xf
  s_waitcnt lgkmcnt(4)
  v_mfma_f32_32x32x16_bf16 v[96:111], v[140:143], v[40:43], v[96:111]
  v_add_f32_dpp v5, v91, v94 wave_ror:1 row_mask:0xf bank_mask:0xf
  v_add_f32_dpp v5, v95, v94 wave_shr:1 row_mask:0xf bank_mask:0xf
  v_add_f32_dpp v6, v2, v81 wave_shr:1 row_mask:0xf bank_mask:0xf bound_ctrl:1
  v_add_f32_dpp v7, v2, v85 wave_ror:1 row_mask:0xf bank_mask:0xf
  v_add_f32_dpp v7, v3, v85 wave_shr:1 row_mask:0xf bank_mask:0xf
  ds_read_b64_tr_b16 v[52:53], v27 offset:2432
  ds_read_b64_tr_b16 v[54:55], v27 offset:2464
  v_mfma_f32_32x32x16_bf16 v[112:127], v[188:191], v[40:43], v[112:127]
  v_add_f32_dpp v8, v3, v89 wave_ror:1 row_mask:0xf bank_mask:0xf
  v_add_f32_dpp v8, v4, v89 wave_shr:1 row_mask:0xf bank_mask:0xf
  v_add_f32_dpp v9, v4, v93 wave_ror:1 row_mask:0xf bank_mask:0xf
  v_add_f32_dpp v9, v5, v93 wave_shr:1 row_mask:0xf bank_mask:0xf
  v_add_f32_dpp v10, v6, v80 wave_shr:1 row_mask:0xf bank_mask:0xf bound_ctrl:1
  s_waitcnt lgkmcnt(4)
  v_mfma_f32_32x32x16_bf16 v[96:111], v[136:139], v[44:47], v[96:111]
  v_add_f32_dpp v11, v6, v84 wave_ror:1 row_mask:0xf bank_mask:0xf
  v_add_f32_dpp v11, v7, v84 wave_shr:1 row_mask:0xf bank_mask:0xf
  v_add_f32_dpp v12, v7, v88 wave_ror:1 row_mask:0xf bank_mask:0xf
  v_add_f32_dpp v12, v8, v88 wave_shr:1 row_mask:0xf bank_mask:0xf
  v_add_f32_dpp v13, v8, v92 wave_ror:1 row_mask:0xf bank_mask:0xf
  ds_read_b64_tr_b16 v[40:41], v27 offset:2560
  ds_read_b64_tr_b16 v[42:43], v27 offset:2592
  v_mfma_f32_32x32x16_bf16 v[112:127], v[184:187], v[44:47], v[112:127]
  v_add_f32_dpp v13, v9, v92 wave_shr:1 row_mask:0xf bank_mask:0xf
  v_cvt_pk_bf16_f32 v14, v10, v11
  v_cvt_pk_bf16_f32 v15, v12, v13
  ds_write_b32 v29, v10 offset:48
  ds_write_b32 v30, v9 offset:64
  ds_read_b64_tr_b16 v[44:45], v27 offset:2688
  ds_read_b64_tr_b16 v[46:47], v27 offset:2720
  s_waitcnt lgkmcnt(8)
  v_mfma_f32_32x32x16_bf16 v[96:111], v[132:135], v[48:51], v[96:111]
  ds_write_b32 v30, v5 offset:68
  ds_write_b32 v30, v95 offset:72
  ds_write_b16 v28, v14 offset:3072
  ds_write_b16_d16_hi v28, v14 offset:3328
  ds_write_b16 v28, v15 offset:3584
  v_mfma_f32_32x32x16_bf16 v[112:127], v[180:183], v[48:51], v[112:127]
  ds_write_b16_d16_hi v28, v15 offset:3840
  s_waitcnt lgkmcnt(12)
  v_mfma_f32_32x32x16_bf16 v[96:111], v[128:131], v[52:55], v[96:111]
  ds_read_b64_tr_b16 v[48:49], v27 offset:2816
  ds_read_b64_tr_b16 v[50:51], v27 offset:2848
  v_mfma_f32_32x32x16_bf16 v[112:127], v[176:179], v[52:55], v[112:127]
  s_waitcnt lgkmcnt(12)
  v_mfma_f32_32x32x16_bf16 v[112:127], v[172:175], v[40:43], v[112:127]
  v_add_f32_dpp v2, v99, v98 wave_shr:1 row_mask:0xf bank_mask:0xf bound_ctrl:1
  v_add_f32_dpp v3, v99, v102 wave_ror:1 row_mask:0xf bank_mask:0xf
  v_add_f32_dpp v3, v103, v102 wave_shr:1 row_mask:0xf bank_mask:0xf
  v_add_f32_dpp v4, v103, v106 wave_ror:1 row_mask:0xf bank_mask:0xf
  v_add_f32_dpp v4, v107, v106 wave_shr:1 row_mask:0xf bank_mask:0xf
  ds_read_b64_tr_b16 v[52:53], v27 offset:2944
  ds_read_b64_tr_b16 v[54:55], v27 offset:2976
  s_waitcnt lgkmcnt(10)
  v_mfma_f32_32x32x16_bf16 v[112:127], v[168:171], v[44:47], v[112:127]
  v_add_f32_dpp v5, v107, v110 wave_ror:1 row_mask:0xf bank_mask:0xf
  v_add_f32_dpp v5, v111, v110 wave_shr:1 row_mask:0xf bank_mask:0xf
  v_add_f32_dpp v6, v2, v97 wave_shr:1 row_mask:0xf bank_mask:0xf bound_ctrl:1
  v_add_f32_dpp v7, v2, v101 wave_ror:1 row_mask:0xf bank_mask:0xf
  v_add_f32_dpp v7, v3, v101 wave_shr:1 row_mask:0xf bank_mask:0xf
  ds_read_b64_tr_b16 v[40:41], v27 offset:3072
  ds_read_b64_tr_b16 v[42:43], v27 offset:3104
  ds_read_b64_tr_b16 v[44:45], v27 offset:3200
  ds_read_b64_tr_b16 v[46:47], v27 offset:3232
  s_waitcnt lgkmcnt(6)
  v_mfma_f32_32x32x16_bf16 v[112:127], v[164:167], v[48:51], v[112:127]
  v_add_f32_dpp v8, v3, v105 wave_ror:1 row_mask:0xf bank_mask:0xf
  v_add_f32_dpp v8, v4, v105 wave_shr:1 row_mask:0xf bank_mask:0xf
  v_add_f32_dpp v9, v4, v109 wave_ror:1 row_mask:0xf bank_mask:0xf
  v_add_f32_dpp v9, v5, v109 wave_shr:1 row_mask:0xf bank_mask:0xf
  v_add_f32_dpp v10, v6, v96 wave_shr:1 row_mask:0xf bank_mask:0xf bound_ctrl:1
  ds_read_b64_tr_b16 v[48:49], v27 offset:3328
  ds_read_b64_tr_b16 v[50:51], v27 offset:3360
  s_waitcnt lgkmcnt(6)
  v_mfma_f32_32x32x16_bf16 v[112:127], v[160:163], v[52:55], v[112:127]
  v_add_f32_dpp v11, v6, v100 wave_ror:1 row_mask:0xf bank_mask:0xf
  v_add_f32_dpp v11, v7, v100 wave_shr:1 row_mask:0xf bank_mask:0xf
  v_add_f32_dpp v12, v7, v104 wave_ror:1 row_mask:0xf bank_mask:0xf
  v_add_f32_dpp v12, v8, v104 wave_shr:1 row_mask:0xf bank_mask:0xf
  v_add_f32_dpp v13, v8, v108 wave_ror:1 row_mask:0xf bank_mask:0xf
  ds_read_b64_tr_b16 v[52:53], v27 offset:3456
  ds_read_b64_tr_b16 v[54:55], v27 offset:3488
  s_waitcnt lgkmcnt(6)
  v_mfma_f32_32x32x16_bf16 v[112:127], v[156:159], v[40:43], v[112:127]
  v_add_f32_dpp v13, v9, v108 wave_shr:1 row_mask:0xf bank_mask:0xf
  v_cvt_pk_bf16_f32 v14, v10, v11
  v_cvt_pk_bf16_f32 v15, v12, v13
  ds_write_b32 v29, v10 offset:64
  ds_write_b32 v30, v9 offset:80
  ds_read_b64_tr_b16 v[40:41], v27 offset:3584
  ds_read_b64_tr_b16 v[42:43], v27 offset:3616
  s_waitcnt lgkmcnt(8)
  v_mfma_f32_32x32x16_bf16 v[112:127], v[152:155], v[44:47], v[112:127]
  ds_write_b32 v30, v5 offset:84
  ds_write_b32 v30, v111 offset:88
  ds_write_b16 v28, v14 offset:4096
  ds_write_b16_d16_hi v28, v14 offset:4352
  ds_write_b16 v28, v15 offset:4608
  s_waitcnt lgkmcnt(11)
  v_mfma_f32_32x32x16_bf16 v[112:127], v[148:151], v[48:51], v[112:127]
  ds_write_b16_d16_hi v28, v15 offset:4864
  ds_read_b64_tr_b16 v[44:45], v27 offset:3712
  ds_read_b64_tr_b16 v[46:47], v27 offset:3744
  s_waitcnt lgkmcnt(12)
  v_mfma_f32_32x32x16_bf16 v[112:127], v[144:147], v[52:55], v[112:127]
  ds_read_b64_tr_b16 v[48:49], v27 offset:3840
  ds_read_b64_tr_b16 v[50:51], v27 offset:3872
  s_waitcnt lgkmcnt(10)
  v_mfma_f32_32x32x16_bf16 v[112:127], v[140:143], v[40:43], v[112:127]
  ds_read_b64_tr_b16 v[52:53], v27 offset:3968
  ds_read_b64_tr_b16 v[54:55], v27 offset:4000
  s_waitcnt lgkmcnt(4)
  v_mfma_f32_32x32x16_bf16 v[112:127], v[136:139], v[44:47], v[112:127]
  s_waitcnt lgkmcnt(2)
  v_mfma_f32_32x32x16_bf16 v[112:127], v[132:135], v[48:51], v[112:127]
  s_waitcnt lgkmcnt(0)
  v_mfma_f32_32x32x16_bf16 v[112:127], v[128:131], v[52:55], v[112:127]
  s_nop 7
  s_nop 3
  v_add_f32_dpp v2, v115, v114 wave_shr:1 row_mask:0xf bank_mask:0xf bound_ctrl:1
  v_add_f32_dpp v3, v115, v118 wave_ror:1 row_mask:0xf bank_mask:0xf
  v_add_f32_dpp v3, v119, v118 wave_shr:1 row_mask:0xf bank_mask:0xf
  v_add_f32_dpp v4, v119, v122 wave_ror:1 row_mask:0xf bank_mask:0xf
  v_add_f32_dpp v4, v123, v122 wave_shr:1 row_mask:0xf bank_mask:0xf
  v_add_f32_dpp v5, v123, v126 wave_ror:1 row_mask:0xf bank_mask:0xf
  v_add_f32_dpp v5, v127, v126 wave_shr:1 row_mask:0xf bank_mask:0xf
  v_add_f32_dpp v6, v2, v113 wave_shr:1 row_mask:0xf bank_mask:0xf bound_ctrl:1
  v_add_f32_dpp v7, v2, v117 wave_ror:1 row_mask:0xf bank_mask:0xf
  v_add_f32_dpp v7, v3, v117 wave_shr:1 row_mask:0xf bank_mask:0xf
  v_add_f32_dpp v8, v3, v121 wave_ror:1 row_mask:0xf bank_mask:0xf
  v_add_f32_dpp v8, v4, v121 wave_shr:1 row_mask:0xf bank_mask:0xf
  v_add_f32_dpp v9, v4, v125 wave_ror:1 row_mask:0xf bank_mask:0xf
  v_add_f32_dpp v9, v5, v125 wave_shr:1 row_mask:0xf bank_mask:0xf
  v_add_f32_dpp v10, v6, v112 wave_shr:1 row_mask:0xf bank_mask:0xf bound_ctrl:1
  v_add_f32_dpp v11, v6, v116 wave_ror:1 row_mask:0xf bank_mask:0xf
  v_add_f32_dpp v11, v7, v116 wave_shr:1 row_mask:0xf bank_mask:0xf
  v_add_f32_dpp v12, v7, v120 wave_ror:1 row_mask:0xf bank_mask:0xf
  v_add_f32_dpp v12, v8, v120 wave_shr:1 row_mask:0xf bank_mask:0xf
  v_add_f32_dpp v13, v8, v124 wave_ror:1 row_mask:0xf bank_mask:0xf
  v_add_f32_dpp v13, v9, v124 wave_shr:1 row_mask:0xf bank_mask:0xf
  v_cvt_pk_bf16_f32 v14, v10, v11
  v_cvt_pk_bf16_f32 v15, v12, v13
  ds_write_b32 v29, v10 offset:112
  ds_write_b16 v28, v14 offset:7168
  ds_write_b16_d16_hi v28, v14 offset:7424
  ds_write_b16 v28, v15 offset:7680
  ds_write_b16_d16_hi v28, v15 offset:7936
  s_branch CV_72
CV_71:
  ds_read_b64_tr_b16 v[40:41], v27 offset:0
  ds_read_b64_tr_b16 v[42:43], v27 offset:32
  ds_read_b64_tr_b16 v[156:157], v26 offset:928
  ds_read_b64_tr_b16 v[158:159], v26 offset:896
  ds_read_b64_tr_b16 v[172:173], v26 offset:1440
  ds_read_b64_tr_b16 v[174:175], v26 offset:1408
  ds_read_b64_tr_b16 v[220:221], v26 offset:2976
  ds_read_b64_tr_b16 v[222:223], v26 offset:2944
  ds_read_b64_tr_b16 v[236:237], v26 offset:3488
  ds_read_b64_tr_b16 v[238:239], v26 offset:3456
  ds_read_b64_tr_b16 v[44:45], v27 offset:128
  ds_read_b64_tr_b16 v[46:47], v27 offset:160
  ds_read_b64_tr_b16 v[152:153], v26 offset:800
  ds_read_b64_tr_b16 v[154:155], v26 offset:768
  s_waitcnt lgkmcnt(10)
  v_mfma_f32_32x32x16_bf16 v[64:79], v[156:159], v[40:43], 0
  ds_read_b64_tr_b16 v[168:169], v26 offset:1312
  ds_read_b64_tr_b16 v[170:171], v26 offset:1280
  ds_read_b64_tr_b16 v[216:217], v26 offset:2848
  ds_read_b64_tr_b16 v[218:219], v26 offset:2816
  s_waitcnt lgkmcnt(12)
  v_mfma_f32_32x32x16_bf16 v[80:95], v[172:175], v[40:43], 0
  ds_read_b64_tr_b16 v[232:233], v26 offset:3360
  ds_read_b64_tr_b16 v[234:235], v26 offset:3328
  s_waitcnt lgkmcnt(12)
  v_mfma_f32_32x32x16_bf16 v[96:111], v[220:223], v[40:43], 0
  ds_read_b64_tr_b16 v[48:49], v27 offset:256
  ds_read_b64_tr_b16 v[50:51], v27 offset:288
  s_waitcnt lgkmcnt(12)
  v_mfma_f32_32x32x16_bf16 v[112:127], v[236:239], v[40:43], 0
  ds_read_b64_tr_b16 v[148:149], v26 offset:672
  ds_read_b64_tr_b16 v[150:151], v26 offset:640
  s_waitcnt lgkmcnt(10)
  v_mfma_f32_32x32x16_bf16 v[64:79], v[152:155], v[44:47], v[64:79]
  ds_read_b64_tr_b16 v[164:165], v26 offset:1184
  ds_read_b64_tr_b16 v[166:167], v26 offset:1152
  ds_read_b64_tr_b16 v[212:213], v26 offset:2720
  ds_read_b64_tr_b16 v[214:215], v26 offset:2688
  s_waitcnt lgkmcnt(12)
  v_mfma_f32_32x32x16_bf16 v[80:95], v[168:171], v[44:47], v[80:95]
  ds_read_b64_tr_b16 v[228:229], v26 offset:3232
  ds_read_b64_tr_b16 v[230:231], v26 offset:3200
  s_waitcnt lgkmcnt(12)
  v_mfma_f32_32x32x16_bf16 v[96:111], v[216:219], v[44:47], v[96:111]
  ds_read_b64_tr_b16 v[52:53], v27 offset:384
  ds_read_b64_tr_b16 v[54:55], v27 offset:416
  s_waitcnt lgkmcnt(12)
  v_mfma_f32_32x32x16_bf16 v[112:127], v[232:235], v[44:47], v[112:127]
  ds_read_b64_tr_b16 v[144:145], v26 offset:544
  ds_read_b64_tr_b16 v[146:147], v26 offset:512
  s_waitcnt lgkmcnt(10)
  v_mfma_f32_32x32x16_bf16 v[64:79], v[148:151], v[48:51], v[64:79]
  ds_read_b64_tr_b16 v[160:161], v26 offset:1056
  ds_read_b64_tr_b16 v[162:163], v26 offset:1024
  ds_read_b64_tr_b16 v[208:209], v26 offset:2592
  ds_read_b64_tr_b16 v[210:211], v26 offset:2560
  s_waitcnt lgkmcnt(12)
  v_mfma_f32_32x32x16_bf16 v[80:95], v[164:167], v[48:51], v[80:95]
  ds_read_b64_tr_b16 v[224:225], v26 offset:3104
  ds_read_b64_tr_b16 v[226:227], v26 offset:3072
  s_waitcnt lgkmcnt(12)
  v_mfma_f32_32x32x16_bf16 v[96:111], v[212:215], v[48:51], v[96:111]
  ds_read_b64_tr_b16 v[40:41], v27 offset:512
  ds_read_b64_tr_b16 v[42:43], v27 offset:544
  s_waitcnt lgkmcnt(12)
  v_mfma_f32_32x32x16_bf16 v[112:127], v[228:231], v[48:51], v[112:127]
  ds_read_b64_tr_b16 v[140:141], v26 offset:416
  ds_read_b64_tr_b16 v[142:143], v26 offset:384
  s_waitcnt lgkmcnt(10)
  v_mfma_f32_32x32x16_bf16 v[64:79], v[144:147], v[52:55], v[64:79]
  s_waitcnt vmcnt(0)
  ds_write_b64 v62, v[20:21]
  ds_read_b64_tr_b16 v[204:205], v26 offset:2464
  ds_read_b64_tr_b16 v[206:207], v26 offset:2432
  s_waitcnt lgkmcnt(11)
  v_mfma_f32_32x32x16_bf16 v[80:95], v[160:163], v[52:55], v[80:95]
  s_waitcnt lgkmcnt(9)
  v_mfma_f32_32x32x16_bf16 v[96:111], v[208:211], v[52:55], v[96:111]
  ds_read_b64_tr_b16 v[44:45], v27 offset:640
  ds_read_b64_tr_b16 v[46:47], v27 offset:672
  ds_read_b64_tr_b16 v[136:137], v26 offset:288
  ds_read_b64_tr_b16 v[138:139], v26 offset:256
  s_waitcnt lgkmcnt(11)
  v_mfma_f32_32x32x16_bf16 v[112:127], v[224:227], v[52:55], v[112:127]
  s_waitcnt lgkmcnt(7)
  v_mfma_f32_32x32x16_bf16 v[64:79], v[140:143], v[40:43], v[64:79]
  ds_read_b64_tr_b16 v[200:201], v26 offset:2336
  ds_read_b64_tr_b16 v[202:203], v26 offset:2304
  v_mfma_f32_32x32x16_bf16 v[80:95], v[156:159], v[40:43], v[80:95]
  s_waitcnt lgkmcnt(6)
  v_mfma_f32_32x32x16_bf16 v[96:111], v[204:207], v[40:43], v[96:111]
  ds_read_b64_tr_b16 v[48:49], v27 offset:768
  ds_read_b64_tr_b16 v[50:51], v27 offset:800
  ds_read_b64_tr_b16 v[132:133], v26 offset:160
  ds_read_b64_tr_b16 v[134:135], v26 offset:128
  v_mfma_f32_32x32x16_bf16 v[112:127], v[220:223], v[40:43], v[112:127]
  s_waitcnt lgkmcnt(6)
  v_mfma_f32_32x32x16_bf16 v[64:79], v[136:139], v[44:47], v[64:79]
  ds_read_b64_tr_b16 v[196:197], v26 offset:2208
  ds_read_b64_tr_b16 v[198:199], v26 offset:2176
  v_mfma_f32_32x32x16_bf16 v[80:95], v[152:155], v[44:47], v[80:95]
  s_waitcnt lgkmcnt(6)
  v_mfma_f32_32x32x16_bf16 v[96:111], v[200:203], v[44:47], v[96:111]
  ds_read_b64_tr_b16 v[52:53], v27 offset:896
  ds_read_b64_tr_b16 v[54:55], v27 offset:928
  ds_read_b64_tr_b16 v[128:129], v26 offset:32
  ds_read_b64_tr_b16 v[130:131], v26 offset:0
  v_mfma_f32_32x32x16_bf16 v[112:127], v[216:219], v[44:47], v[112:127]
  s_waitcnt lgkmcnt(6)
  v_mfma_f32_32x32x16_bf16 v[64:79], v[132:135], v[48:51], v[64:79]
  ds_read_b64_tr_b16 v[192:193], v26 offset:2080
  ds_read_b64_tr_b16 v[194:195], v26 offset:2048
  v_mfma_f32_32x32x16_bf16 v[80:95], v[148:151], v[48:51], v[80:95]
  s_waitcnt lgkmcnt(6)
  v_mfma_f32_32x32x16_bf16 v[96:111], v[196:199], v[48:51], v[96:111]
  ds_read_b64_tr_b16 v[40:41], v27 offset:1024
  ds_read_b64_tr_b16 v[42:43], v27 offset:1056
  v_mfma_f32_32x32x16_bf16 v[112:127], v[212:215], v[48:51], v[112:127]
  ds_read_b64_tr_b16 v[188:189], v26 offset:1952
  ds_read_b64_tr_b16 v[190:191], v26 offset:1920
  s_waitcnt lgkmcnt(6)
  v_mfma_f32_32x32x16_bf16 v[64:79], v[128:131], v[52:55], v[64:79]
  v_mfma_f32_32x32x16_bf16 v[80:95], v[144:147], v[52:55], v[80:95]
  ds_read_b64_tr_b16 v[44:45], v27 offset:1152
  ds_read_b64_tr_b16 v[46:47], v27 offset:1184
  s_waitcnt lgkmcnt(6)
  v_mfma_f32_32x32x16_bf16 v[96:111], v[192:195], v[52:55], v[96:111]
  v_add_f32_dpp v2, v67, v66 wave_shr:1 row_mask:0xf bank_mask:0xf bound_ctrl:1
  v_add_f32_dpp v3, v67, v70 wave_ror:1 row_mask:0xf bank_mask:0xf
  v_add_f32_dpp v3, v71, v70 wave_shr:1 row_mask:0xf bank_mask:0xf
  v_add_f32_dpp v4, v71, v74 wave_ror:1 row_mask:0xf bank_mask:0xf
  v_add_f32_dpp v4, v75, v74 wave_shr:1 row_mask:0xf bank_mask:0xf
  ds_read_b64_tr_b16 v[184:185], v26 offset:1824
  ds_read_b64_tr_b16 v[186:187], v26 offset:1792
  v_mfma_f32_32x32x16_bf16 v[112:127], v[208:211], v[52:55], v[112:127]
  v_add_f32_dpp v5, v75, v78 wave_ror:1 row_mask:0xf bank_mask:0xf
  v_add_f32_dpp v5, v79, v78 wave_shr:1 row_mask:0xf bank_mask:0xf
  v_add_f32_dpp v6, v2, v65 wave_shr:1 row_mask:0xf bank_mask:0xf bound_ctrl:1
  v_add_f32_dpp v7, v2, v69 wave_ror:1 row_mask:0xf bank_mask:0xf
  v_add_f32_dpp v7, v3, v69 wave_shr:1 row_mask:0xf bank_mask:0xf
  s_waitcnt lgkmcnt(6)
  v_mfma_f32_32x32x16_bf16 v[80:95], v[140:143], v[40:43], v[80:95]
  v_add_f32_dpp v8, v3, v73 wave_ror:1 row_mask:0xf bank_mask:0xf
  v_add_f32_dpp v8, v4, v73 wave_shr:1 row_mask:0xf bank_mask:0xf
  v_add_f32_dpp v9, v4, v77 wave_ror:1 row_mask:0xf bank_mask:0xf
  v_add_f32_dpp v9, v5, v77 wave_shr:1 row_mask:0xf bank_mask:0xf
  v_add_f32_dpp v10, v6, v64 wave_shr:1 row_mask:0xf bank_mask:0xf bound_ctrl:1
  ds_read_b64_tr_b16 v[48:49], v27 offset:1280
  ds_read_b64_tr_b16 v[50:51], v27 offset:1312
  s_waitcnt lgkmcnt(6)
  v_mfma_f32_32x32x16_bf16 v[96:111], v[188:191], v[40:43], v[96:111]
  v_add_f32_dpp v11, v6, v68 wave_ror:1 row_mask:0xf bank_mask:0xf
  v_add_f32_dpp v11, v7, v68 wave_shr:1 row_mask:0xf bank_mask:0xf
  v_add_f32_dpp v12, v7, v72 wave_ror:1 row_mask:0xf bank_mask:0xf
  v_add_f32_dpp v12, v8, v72 wave_shr:1 row_mask:0xf bank_mask:0xf
  v_add_f32_dpp v13, v8, v76 wave_ror:1 row_mask:0xf bank_mask:0xf
  ds_read_b64_tr_b16 v[180:181], v26 offset:1696
  ds_read_b64_tr_b16 v[182:183], v26 offset:1664
  v_mfma_f32_32x32x16_bf16 v[112:127], v[204:207], v[40:43], v[112:127]
  v_add_f32_dpp v13, v9, v76 wave_shr:1 row_mask:0xf bank_mask:0xf
  v_cvt_pk_bf16_f32 v14, v10, v11
  v_cvt_pk_bf16_f32 v15, v12, v13
  ds_write_b32 v29, v10 offset:16
  ds_write_b32 v30, v9 offset:32
  s_waitcnt lgkmcnt(8)
  v_mfma_f32_32x32x16_bf16 v[80:95], v[136:139], v[44:47], v[80:95]
  ds_write_b32 v30, v5 offset:36
  ds_write_b32 v30, v79 offset:40
  ds_write_b16 v28, v14 offset:1024
  ds_write_b16_d16_hi v28, v14 offset:1280
  ds_write_b16 v28, v15 offset:1536
  s_waitcnt lgkmcnt(11)
  v_mfma_f32_32x32x16_bf16 v[96:111], v[184:187], v[44:47], v[96:111]
  ds_write_b16_d16_hi v28, v15 offset:1792
  ds_read_b64_tr_b16 v[52:53], v27 offset:1408
  ds_read_b64_tr_b16 v[54:55], v27 offset:1440
  v_mfma_f32_32x32x16_bf16 v[112:127], v[200:203], v[44:47], v[112:127]
  s_waitcnt lgkmcnt(12)
  v_mfma_f32_32x32x16_bf16 v[80:95], v[132:135], v[48:51], v[80:95]
  ds_read_b64_tr_b16 v[176:177], v26 offset:1568
  ds_read_b64_tr_b16 v[178:179], v26 offset:1536
  s_waitcnt lgkmcnt(12)
  v_mfma_f32_32x32x16_bf16 v[96:111], v[180:183], v[48:51], v[96:111]
  ds_read_b64_tr_b16 v[40:41], v27 offset:1536
  ds_read_b64_tr_b16 v[42:43], v27 offset:1568
  v_mfma_f32_32x32x16_bf16 v[112:127], v[196:199], v[48:51], v[112:127]
  s_waitcnt lgkmcnt(4)
  v_mfma_f32_32x32x16_bf16 v[80:95], v[128:131], v[52:55], v[80:95]
  ds_read_b64_tr_b16 v[44:45], v27 offset:1664
  ds_read_b64_tr_b16 v[46:47], v27 offset:1696
  s_waitcnt lgkmcnt(4)
  v_mfma_f32_32x32x16_bf16 v[96:111], v[176:179], v[52:55], v[96:111]
  ds_read_b64_tr_b16 v[48:49], v27 offset:1792
  ds_read_b64_tr_b16 v[50:51], v27 offset:1824
  v_mfma_f32_32x32x16_bf16 v[112:127], v[192:195], v[52:55], v[112:127]
  v_add_f32_dpp v2, v83, v82 wave_shr:1 row_mask:0xf bank_mask:0xf bound_ctrl:1
  v_add_f32_dpp v3, v83, v86 wave_ror:1 row_mask:0xf bank_mask:0xf
  v_add_f32_dpp v3, v87, v86 wave_shr:1 row_mask:0xf bank_mask:0xf
  v_add_f32_dpp v4, v87, v90 wave_ror:1 row_mask:0xf bank_mask:0xf
  v_add_f32_dpp v4, v91, v90 wave_shr:1 row_mask:0xf bank_mask:0xf
  s_waitcnt lgkmcnt(4)
  v_mfma_f32_32x32x16_bf16 v[96:111], v[172:175], v[40:43], v[96:111]
  v_add_f32_dpp v5, v91, v94 wave_ror:1 row_mask:0xf bank_mask:0xf
  v_add_f32_dpp v5, v95, v94 wave_shr:1 row_mask:0xf bank_mask:0xf
  v_add_f32_dpp v6, v2, v81 wave_shr:1 row_mask:0xf bank_mask:0xf bound_ctrl:1
  v_add_f32_dpp v7, v2, v85 wave_ror:1 row_mask:0xf bank_mask:0xf
  v_add_f32_dpp v7, v3, v85 wave_shr:1 row_mask:0xf bank_mask:0xf
  ds_read_b64_tr_b16 v[52:53], v27 offset:1920
  ds_read_b64_tr_b16 v[54:55], v27 offset:1952
  v_mfma_f32_32x32x16_bf16 v[112:127], v[188:191], v[40:43], v[112:127]
  v_add_f32_dpp v8, v3, v89 wave_ror:1 row_mask:0xf bank_mask:0xf
  v_add_f32_dpp v8, v4, v89 wave_shr:1 row_mask:0xf bank_mask:0xf
  v_add_f32_dpp v9, v4, v93 wave_ror:1 row_mask:0xf bank_mask:0xf
  v_add_f32_dpp v9, v5, v93 wave_shr:1 row_mask:0xf bank_mask:0xf
  v_add_f32_dpp v10, v6, v80 wave_shr:1 row_mask:0xf bank_mask:0xf bound_ctrl:1
  s_waitcnt lgkmcnt(4)
  v_mfma_f32_32x32x16_bf16 v[96:111], v[168:171], v[44:47], v[96:111]
  v_add_f32_dpp v11, v6, v84 wave_ror:1 row_mask:0xf bank_mask:0xf
  v_add_f32_dpp v11, v7, v84 wave_shr:1 row_mask:0xf bank_mask:0xf
  v_add_f32_dpp v12, v7, v88 wave_ror:1 row_mask:0xf bank_mask:0xf
  v_add_f32_dpp v12, v8, v88 wave_shr:1 row_mask:0xf bank_mask:0xf
  v_add_f32_dpp v13, v8, v92 wave_ror:1 row_mask:0xf bank_mask:0xf
  ds_read_b64_tr_b16 v[40:41], v27 offset:2048
  ds_read_b64_tr_b16 v[42:43], v27 offset:2080
  v_mfma_f32_32x32x16_bf16 v[112:127], v[184:187], v[44:47], v[112:127]
  v_add_f32_dpp v13, v9, v92 wave_shr:1 row_mask:0xf bank_mask:0xf
  v_cvt_pk_bf16_f32 v14, v10, v11
  v_cvt_pk_bf16_f32 v15, v12, v13
  ds_write_b32 v29, v10 offset:32
  ds_write_b32 v30, v9 offset:48
  s_waitcnt lgkmcnt(6)
  v_mfma_f32_32x32x16_bf16 v[96:111], v[164:167], v[48:51], v[96:111]
  ds_write_b32 v30, v5 offset:52
  ds_write_b32 v30, v95 offset:56
  ds_write_b16 v28, v14 offset:2048
  ds_write_b16_d16_hi v28, v14 offset:2304
  ds_write_b16 v28, v15 offset:2560
  ds_read_b64_tr_b16 v[44:45], v27 offset:2176
  ds_read_b64_tr_b16 v[46:47], v27 offset:2208
  v_mfma_f32_32x32x16_bf16 v[112:127], v[180:183], v[48:51], v[112:127]
  ds_write_b16_d16_hi v28, v15 offset:2816
  s_waitcnt lgkmcnt(12)
  v_mfma_f32_32x32x16_bf16 v[96:111], v[160:163], v[52:55], v[96:111]
  ds_read_b64_tr_b16 v[48:49], v27 offset:2304
  ds_read_b64_tr_b16 v[50:51], v27 offset:2336
  v_mfma_f32_32x32x16_bf16 v[112:127], v[176:179], v[52:55], v[112:127]
  s_waitcnt lgkmcnt(12)
  v_mfma_f32_32x32x16_bf16 v[96:111], v[156:159], v[40:43], v[96:111]
  ds_read_b64_tr_b16 v[52:53], v27 offset:2432
  ds_read_b64_tr_b16 v[54:55], v27 offset:2464
  v_mfma_f32_32x32x16_bf16 v[112:127], v[172:175], v[40:43], v[112:127]
  s_waitcnt lgkmcnt(5)
  v_mfma_f32_32x32x16_bf16 v[96:111], v[152:155], v[44:47], v[96:111]
  ds_read_b64_tr_b16 v[40:41], v27 offset:2560
  ds_read_b64_tr_b16 v[42:43], v27 offset:2592
  v_mfma_f32_32x32x16_bf16 v[112:127], v[168:171], v[44:47], v[112:127]
  s_waitcnt lgkmcnt(4)
  v_mfma_f32_32x32x16_bf16 v[96:111], v[148:151], v[48:51], v[96:111]
  ds_read_b64_tr_b16 v[44:45], v27 offset:2688
  ds_read_b64_tr_b16 v[46:47], v27 offset:2720
  v_mfma_f32_32x32x16_bf16 v[112:127], v[164:167], v[48:51], v[112:127]
  s_waitcnt lgkmcnt(4)
  v_mfma_f32_32x32x16_bf16 v[96:111], v[144:147], v[52:55], v[96:111]
  ds_read_b64_tr_b16 v[48:49], v27 offset:2816
  ds_read_b64_tr_b16 v[50:51], v27 offset:2848
  v_mfma_f32_32x32x16_bf16 v[112:127], v[160:163], v[52:55], v[112:127]
  s_waitcnt lgkmcnt(4)
  v_mfma_f32_32x32x16_bf16 v[96:111], v[140:143], v[40:43], v[96:111]
  ds_read_b64_tr_b16 v[52:53], v27 offset:2944
  ds_read_b64_tr_b16 v[54:55], v27 offset:2976
  v_mfma_f32_32x32x16_bf16 v[112:127], v[156:159], v[40:43], v[112:127]
  s_waitcnt lgkmcnt(4)
  v_mfma_f32_32x32x16_bf16 v[96:111], v[136:139], v[44:47], v[96:111]
  ds_read_b64_tr_b16 v[40:41], v27 offset:3072
  ds_read_b64_tr_b16 v[42:43], v27 offset:3104
  v_mfma_f32_32x32x16_bf16 v[112:127], v[152:155], v[44:47], v[112:127]
  ds_read_b64_tr_b16 v[44:45], v27 offset:3200
  ds_read_b64_tr_b16 v[46:47], v27 offset:3232
  s_waitcnt lgkmcnt(6)
  v_mfma_f32_32x32x16_bf16 v[96:111], v[132:135], v[48:51], v[96:111]
  v_mfma_f32_32x32x16_bf16 v[112:127], v[148:151], v[48:51], v[112:127]
  ds_read_b64_tr_b16 v[48:49], v27 offset:3328
  ds_read_b64_tr_b16 v[50:51], v27 offset:3360
  s_waitcnt lgkmcnt(6)
  v_mfma_f32_32x32x16_bf16 v[96:111], v[128:131], v[52:55], v[96:111]
  v_mfma_f32_32x32x16_bf16 v[112:127], v[144:147], v[52:55], v[112:127]
  ds_read_b64_tr_b16 v[52:53], v27 offset:3456
  ds_read_b64_tr_b16 v[54:55], v27 offset:3488
  s_waitcnt lgkmcnt(6)
  v_mfma_f32_32x32x16_bf16 v[112:127], v[140:143], v[40:43], v[112:127]
  v_add_f32_dpp v2, v99, v98 wave_shr:1 row_mask:0xf bank_mask:0xf bound_ctrl:1
  v_add_f32_dpp v3, v99, v102 wave_ror:1 row_mask:0xf bank_mask:0xf
  v_add_f32_dpp v3, v103, v102 wave_shr:1 row_mask:0xf bank_mask:0xf
  v_add_f32_dpp v4, v103, v106 wave_ror:1 row_mask:0xf bank_mask:0xf
  v_add_f32_dpp v4, v107, v106 wave_shr:1 row_mask:0xf bank_mask:0xf
  s_waitcnt lgkmcnt(4)
  v_mfma_f32_32x32x16_bf16 v[112:127], v[136:139], v[44:47], v[112:127]
  v_add_f32_dpp v5, v107, v110 wave_ror:1 row_mask:0xf bank_mask:0xf
  v_add_f32_dpp v5, v111, v110 wave_shr:1 row_mask:0xf bank_mask:0xf
  v_add_f32_dpp v6, v2, v97 wave_shr:1 row_mask:0xf bank_mask:0xf bound_ctrl:1
  v_add_f32_dpp v7, v2, v101 wave_ror:1 row_mask:0xf bank_mask:0xf
  v_add_f32_dpp v7, v3, v101 wave_shr:1 row_mask:0xf bank_mask:0xf
  s_waitcnt lgkmcnt(2)
  v_mfma_f32_32x32x16_bf16 v[112:127], v[132:135], v[48:51], v[112:127]
  v_add_f32_dpp v8, v3, v105 wave_ror:1 row_mask:0xf bank_mask:0xf
  v_add_f32_dpp v8, v4, v105 wave_shr:1 row_mask:0xf bank_mask:0xf
  v_add_f32_dpp v9, v4, v109 wave_ror:1 row_mask:0xf bank_mask:0xf
  v_add_f32_dpp v9, v5, v109 wave_shr:1 row_mask:0xf bank_mask:0xf
  v_add_f32_dpp v10, v6, v96 wave_shr:1 row_mask:0xf bank_mask:0xf bound_ctrl:1
  s_waitcnt lgkmcnt(0)
  v_mfma_f32_32x32x16_bf16 v[112:127], v[128:131], v[52:55], v[112:127]
  v_add_f32_dpp v11, v6, v100 wave_ror:1 row_mask:0xf bank_mask:0xf
  v_add_f32_dpp v11, v7, v100 wave_shr:1 row_mask:0xf bank_mask:0xf
  v_add_f32_dpp v12, v7, v104 wave_ror:1 row_mask:0xf bank_mask:0xf
  v_add_f32_dpp v12, v8, v104 wave_shr:1 row_mask:0xf bank_mask:0xf
  v_add_f32_dpp v13, v8, v108 wave_ror:1 row_mask:0xf bank_mask:0xf
  v_add_f32_dpp v13, v9, v108 wave_shr:1 row_mask:0xf bank_mask:0xf
  v_cvt_pk_bf16_f32 v14, v10, v11
  v_cvt_pk_bf16_f32 v15, v12, v13
  ds_write_b32 v29, v10 offset:80
  ds_write_b32 v30, v9 offset:96
  ds_write_b32 v30, v5 offset:100
  ds_write_b32 v30, v111 offset:104
  ds_write_b16 v28, v14 offset:5120
  ds_write_b16_d16_hi v28, v14 offset:5376
  ds_write_b16 v28, v15 offset:5632
  ds_write_b16_d16_hi v28, v15 offset:5888
  s_nop 7
  s_nop 3
  v_add_f32_dpp v2, v115, v114 wave_shr:1 row_mask:0xf bank_mask:0xf bound_ctrl:1
  v_add_f32_dpp v3, v115, v118 wave_ror:1 row_mask:0xf bank_mask:0xf
  v_add_f32_dpp v3, v119, v118 wave_shr:1 row_mask:0xf bank_mask:0xf
  v_add_f32_dpp v4, v119, v122 wave_ror:1 row_mask:0xf bank_mask:0xf
  v_add_f32_dpp v4, v123, v122 wave_shr:1 row_mask:0xf bank_mask:0xf
  v_add_f32_dpp v5, v123, v126 wave_ror:1 row_mask:0xf bank_mask:0xf
  v_add_f32_dpp v5, v127, v126 wave_shr:1 row_mask:0xf bank_mask:0xf
  v_add_f32_dpp v6, v2, v113 wave_shr:1 row_mask:0xf bank_mask:0xf bound_ctrl:1
  v_add_f32_dpp v7, v2, v117 wave_ror:1 row_mask:0xf bank_mask:0xf
  v_add_f32_dpp v7, v3, v117 wave_shr:1 row_mask:0xf bank_mask:0xf
  v_add_f32_dpp v8, v3, v121 wave_ror:1 row_mask:0xf bank_mask:0xf
  v_add_f32_dpp v8, v4, v121 wave_shr:1 row_mask:0xf bank_mask:0xf
  v_add_f32_dpp v9, v4, v125 wave_ror:1 row_mask:0xf bank_mask:0xf
  v_add_f32_dpp v9, v5, v125 wave_shr:1 row_mask:0xf bank_mask:0xf
  v_add_f32_dpp v10, v6, v112 wave_shr:1 row_mask:0xf bank_mask:0xf bound_ctrl:1
  v_add_f32_dpp v11, v6, v116 wave_ror:1 row_mask:0xf bank_mask:0xf
  v_add_f32_dpp v11, v7, v116 wave_shr:1 row_mask:0xf bank_mask:0xf
  v_add_f32_dpp v12, v7, v120 wave_ror:1 row_mask:0xf bank_mask:0xf
  v_add_f32_dpp v12, v8, v120 wave_shr:1 row_mask:0xf bank_mask:0xf
  v_add_f32_dpp v13, v8, v124 wave_ror:1 row_mask:0xf bank_mask:0xf
  v_add_f32_dpp v13, v9, v124 wave_shr:1 row_mask:0xf bank_mask:0xf
  v_cvt_pk_bf16_f32 v14, v10, v11
  v_cvt_pk_bf16_f32 v15, v12, v13
  ds_write_b32 v29, v10 offset:96
  ds_write_b32 v30, v9 offset:112
  ds_write_b32 v30, v5 offset:116
  ds_write_b32 v30, v127 offset:120
  ds_write_b16 v28, v14 offset:6144
  ds_write_b16_d16_hi v28, v14 offset:6400
  ds_write_b16 v28, v15 offset:6656
  ds_write_b16_d16_hi v28, v15 offset:6912
CV_72:
  s_setprio 3
  s_waitcnt lgkmcnt(0)
  v_mov_b32 v24, 3
  ds_write_b32 v22, v24
  ds_read_b32 v24, v23
  s_waitcnt lgkmcnt(0)
  v_cmp_gt_u32 vcc, 3, v24
  s_cbranch_vccz SWD_74
SW_73:
  s_sleep 1
  ds_read_b32 v24, v23
  s_waitcnt lgkmcnt(0)
  v_cmp_gt_u32 vcc, 3, v24
  s_cbranch_vccnz SW_73
SWD_74:
  v_bfe_u32 v8, v1, 3, 1
  v_bfe_u32 v9, v1, 2, 1
  v_and_b32 v10, 3, v1
  v_lshl_add_u32 v8, v8, 2, s26
  v_lshl_add_u32 v11, v8, 2, v10
  v_lshlrev_b32 v11, 2, v11
  v_lshl_add_u32 v12, v9, 7, v11
  v_mul_u32_u24 v13, 144, v9
  v_add_u32 v13, v13, v11
  v_add_u32 v12, 157760, v12
  v_add_u32 v13, 158016, v13
  ds_read_b32 v12, v12
  ds_read_b32 v13, v13
  v_lshl_add_u32 v8, v8, 8, v10
  v_lshl_add_u32 v8, v8, 1, v9
  v_lshlrev_b32 v8, 1, v8
  v_add_u32 v8, 148480, v8
  s_lshl_b32 s68, s26, 10
  s_add_u32 s67, s68, 148480
  v_lshl_add_u32 v9, v1, 4, s67
  v_lshlrev_b32 v10, 4, v1
  s_lshl_b32 s67, s64, 13
  s_add_u32 s67, s67, s68
  s_add_u32 s67, s67, 10485760
  s_add_u32 s68, s67, 4096
  s_waitcnt lgkmcnt(0)
  v_add_f32 v12, v12, v13
  v_cvt_pk_bf16_f32 v12, v12, v12
  ds_write_b16 v8, v12
  ds_read_b128 v[64:67], v9
  ds_read_b128 v[68:71], v9 offset:4096
  s_waitcnt lgkmcnt(1)
  buffer_store_dwordx4 v[64:67], v10, s[16:19], s67 offen sc1
  s_waitcnt lgkmcnt(0)
  buffer_store_dwordx4 v[68:71], v10, s[16:19], s68 offen sc1
  s_lshl_b32 s80, s64, 8
  s_lshl_b32 s67, s26, 16
  s_add_u32 s80, s80, s67
  s_add_u32 s80, s80, 12779520
  s_and_b32 s72, s24, 6
  s_lshl_b32 s72, s72, 1
  s_and_b32 s67, s25, 3
  s_add_u32 s72, s72, s67
  s_lshl_b32 s72, s72, 1
  s_and_b32 s67, s24, 1
  s_add_u32 s72, s72, s67
  s_lshr_b32 s73, s25, 2
  s_lshl_b32 s74, s72, 1
  s_add_u32 s74, s74, s66
  s_lshl_b32 s75, s73, 1
  s_add_u32 s75, s75, s65
  s_bfe_u32 s67, s72, 0x20002
  s_lshl_b32 s67, s67, 16
  s_lshl_b32 s68, s75, 12
  s_add_u32 s67, s67, s68
  s_add_u32 s67, s67, 12779520
  v_lshl_add_u32 v2, v1, 8, s67
  s_lshl_b32 s67, s74, 9
  s_add_u32 s67, s67, 12746752
  v_and_b32 v3, 1, v1
  v_lshl_add_u32 v3, v3, 8, s67
  v_cmp_gt_u32 vcc, 16, v1
  v_and_b32 v10, 31, v1
  v_lshrrev_b32 v11, 5, v1
  v_cndmask_b32 v2, v3, v2, vcc
  v_lshlrev_b32 v4, 14, v11
  v_lshl_add_u32 v12, v10, 2, v4
  v_add_u32 v13, 8192, v12
  s_lshl_b32 s67, s74, 8
  s_add_u32 s67, s67, 12582912
  v_lshl_add_u32 v14, v10, 3, s67
  s_lshl_b32 s78, s75, 17
  s_lshl_b32 s68, s74, 7
  s_add_u32 s78, s78, s68
  s_add_u32 s78, s78, 10485760
  v_lshlrev_b32 v16, 4, v1
  s_lshl_b32 s67, s26, 12
  s_add_u32 s67, s67, 131072
  v_add_u32 v18, s67, v16
  s_lshl_b32 s67, s26, 8
  s_add_u32 s67, s67, 147456
  v_lshl_add_u32 v19, v1, 2, s67
  s_lshl_b32 s67, s2, 2
  s_add_u32 s67, s67, s26
  s_lshl_b32 s76, s67, 12
  s_add_u32 s76, s76, 16777216
  s_xor_b32 s79, s76, 16384
  s_xor_b32 s66, s66, 1
  s_lshl_b32 s67, s66, 15
  s_lshl_b32 s68, s65, 12
  s_add_u32 s67, s67, s68
  v_add_u32 v17, s67, v16
  v_xor_b32 v15, 69632, v17
  s_lshl_b32 s67, s66, 2
  s_add_u32 s67, s67, 162832
  v_and_b32 v5, 1, v1
  v_lshl_add_u32 v5, v5, 3, s67
  v_mov_b32 v97, v32
  v_mov_b32 v99, v32
  v_mov_b32 v101, v32
  v_mov_b32 v103, v32
  v_mov_b32 v105, v32
  v_mov_b32 v107, v32
  v_mov_b32 v109, v32
  v_mov_b32 v111, v32
  s_waitcnt vmcnt(0)
  v_mov_b32 v8, 0
  s_mov_b64 exec, 1
  buffer_store_dword v32, v8, s[16:19], s80 offen sc1
  s_mov_b64 exec, -1
  ds_read_b32 v31, v5 offset:0
  s_waitcnt lgkmcnt(0)
  v_cmp_gt_u32 vcc, 9, v31
  s_cbranch_vccz LWD_76
LW_75:
  s_sleep 2
  ds_read_b32 v31, v5 offset:0
  s_waitcnt lgkmcnt(0)
  v_cmp_gt_u32 vcc, 9, v31
  s_cbranch_vccnz LW_75
LWD_76:
  s_mov_b32 s85, 100000
PA_77:
  buffer_load_dword v9, v2, s[16:19], 0 offen sc1
  s_waitcnt vmcnt(0)
  v_cmp_ne_u32 vcc, v32, v9
  s_cbranch_vccz PA_78
  s_sleep 4
  s_sub_u32 s85, s85, 1
  s_cbranch_scc0 PA_77
PA_78:
  buffer_load_dword v136, v12, s[16:19], s78 offen sc1
  buffer_load_dword v137, v13, s[16:19], s78 offen sc1
  s_add_u32 s78, s78, 32768
  buffer_load_dword v138, v12, s[16:19], s78 offen sc1
  buffer_load_dword v139, v13, s[16:19], s78 offen sc1
  s_add_u32 s78, s78, 32768
  buffer_load_dword v140, v12, s[16:19], s78 offen sc1
  buffer_load_dword v141, v13, s[16:19], s78 offen sc1
  s_add_u32 s78, s78, 32768
  buffer_load_dword v142, v12, s[16:19], s78 offen sc1
  buffer_load_dword v143, v13, s[16:19], s78 offen sc1
  buffer_load_dwordx2 v[144:145], v14, s[16:19], 0 offen sc1
  ds_read_b32 v31, v5 offset:0
  s_waitcnt lgkmcnt(0)
  v_cmp_gt_u32 vcc, 10, v31
  s_cbranch_vccz LWD_80
LW_79:
  s_sleep 1
  ds_read_b32 v31, v5 offset:0
  s_waitcnt lgkmcnt(0)
  v_cmp_gt_u32 vcc, 10, v31
  s_cbranch_vccnz LW_79
LWD_80:
  ds_read_b128 v[64:67], v17 offset:0
  ds_read_b128 v[80:83], v15 offset:0
  ds_read_b128 v[68:71], v17 offset:1024
  ds_read_b128 v[84:87], v15 offset:1024
  ds_read_b128 v[72:75], v17 offset:2048
  ds_read_b128 v[88:91], v15 offset:2048
  ds_read_b128 v[76:79], v17 offset:3072
  ds_read_b128 v[92:95], v15 offset:3072
  s_waitcnt vmcnt(0)
  ds_write_b32 v19, v145
  v_lshlrev_b32 v160, 16, v136
  v_and_b32 v161, 0xffff0000, v136
  v_lshlrev_b32 v162, 16, v137
  v_and_b32 v163, 0xffff0000, v137
  v_lshlrev_b32 v164, 16, v138
  v_and_b32 v165, 0xffff0000, v138
  v_lshlrev_b32 v166, 16, v139
  v_and_b32 v167, 0xffff0000, v139
  v_lshlrev_b32 v168, 16, v140
  v_and_b32 v169, 0xffff0000, v140
  v_lshlrev_b32 v170, 16, v141
  v_and_b32 v171, 0xffff0000, v141
  v_lshlrev_b32 v172, 16, v142
  v_and_b32 v173, 0xffff0000, v142
  v_lshlrev_b32 v174, 16, v143
  v_and_b32 v175, 0xffff0000, v143
  v_pk_mul_f32 v[160:161], v[160:161], v[144:145] op_sel:[0,0] op_sel_hi:[1,0]
  v_pk_mul_f32 v[162:163], v[162:163], v[144:145] op_sel:[0,0] op_sel_hi:[1,0]
  v_pk_mul_f32 v[164:165], v[164:165], v[144:145] op_sel:[0,0] op_sel_hi:[1,0]
  v_pk_mul_f32 v[166:167], v[166:167], v[144:145] op_sel:[0,0] op_sel_hi:[1,0]
  v_pk_mul_f32 v[168:169], v[168:169], v[144:145] op_sel:[0,0] op_sel_hi:[1,0]
  v_pk_mul_f32 v[170:171], v[170:171], v[144:145] op_sel:[0,0] op_sel_hi:[1,0]
  v_pk_mul_f32 v[172:173], v[172:173], v[144:145] op_sel:[0,0] op_sel_hi:[1,0]
  v_pk_mul_f32 v[174:175], v[174:175], v[144:145] op_sel:[0,0] op_sel_hi:[1,0]
  s_waitcnt lgkmcnt(7)
  v_pk_add_f32 v[64:65], v[64:65], v[80:81]
  v_pk_add_f32 v[66:67], v[66:67], v[82:83]
  v_pk_fma_f32 v[160:161], v[64:65], v[144:145], v[160:161] op_sel:[0,1,0] op_sel_hi:[1,1,1]
  v_pk_fma_f32 v[162:163], v[66:67], v[144:145], v[162:163] op_sel:[0,1,0] op_sel_hi:[1,1,1]
  ds_write_b128 v18, v[160:163] offset:0
  s_waitcnt lgkmcnt(6)
  v_pk_add_f32 v[68:69], v[68:69], v[84:85]
  v_pk_add_f32 v[70:71], v[70:71], v[86:87]
  v_pk_fma_f32 v[164:165], v[68:69], v[144:145], v[164:165] op_sel:[0,1,0] op_sel_hi:[1,1,1]
  v_pk_fma_f32 v[166:167], v[70:71], v[144:145], v[166:167] op_sel:[0,1,0] op_sel_hi:[1,1,1]
  ds_write_b128 v18, v[164:167] offset:1024
  s_waitcnt lgkmcnt(5)
  v_pk_add_f32 v[72:73], v[72:73], v[88:89]
  v_pk_add_f32 v[74:75], v[74:75], v[90:91]
  v_pk_fma_f32 v[168:169], v[72:73], v[144:145], v[168:169] op_sel:[0,1,0] op_sel_hi:[1,1,1]
  v_pk_fma_f32 v[170:171], v[74:75], v[144:145], v[170:171] op_sel:[0,1,0] op_sel_hi:[1,1,1]
  ds_write_b128 v18, v[168:171] offset:2048
  s_waitcnt lgkmcnt(4)
  v_pk_add_f32 v[76:77], v[76:77], v[92:93]
  v_pk_add_f32 v[78:79], v[78:79], v[94:95]
  v_pk_fma_f32 v[172:173], v[76:77], v[144:145], v[172:173] op_sel:[0,1,0] op_sel_hi:[1,1,1]
  v_pk_fma_f32 v[174:175], v[78:79], v[144:145], v[174:175] op_sel:[0,1,0] op_sel_hi:[1,1,1]
  ds_write_b128 v18, v[172:175] offset:3072
  v_mov_b32 v24, 100
  ds_write_b32 v22, v24
  s_waitcnt lgkmcnt(0)
K_END:
  s_endpgm
.section .rodata,"a"
.p2align 6
.amdhsa_kernel gated_mix__ssm_conv_s4d__dense_activation_silu__prompt_kernel
  .amdhsa_next_free_vgpr 256
  .amdhsa_next_free_sgpr 102
  .amdhsa_accum_offset 256
  .amdhsa_group_segment_fixed_size 0
  .amdhsa_kernarg_size 112
  .amdhsa_user_sgpr_count 2
  .amdhsa_user_sgpr_kernarg_segment_ptr 1
  .amdhsa_system_sgpr_workgroup_id_x 1
.end_amdhsa_kernel
```
